```python
import torch

def _softmax(x, axis=-1):
    return torch.softmax(x, dim=axis)
def _gelu(x):
    return torch.nn.functional.gelu(x, approximate="tanh")
def _silu(x):
    return torch.nn.functional.silu(x)
def _sigmoid(x):
    return torch.sigmoid(x)
def _layernorm(x, axis=-1, eps=1e-5):
    m = x.mean(dim=axis, keepdim=True)
    v = x.var(dim=axis, keepdim=True, unbiased=False)
    return (x - m) / torch.sqrt(v + eps)
def _scatter_add(tgt, idx, src, axis=0):
    return tgt.clone().index_add_(axis, idx, src)
def _segment_sum(src, seg, n):
    out = torch.zeros((n,) + src.shape[1:], dtype=src.dtype)
    return out.index_add_(0, seg, src)
def _pad(x, pw):
    flat = tuple(v for pair in reversed(pw) for v in pair)
    return torch.nn.functional.pad(x, flat)

kernel_name = 'interleave_layers__sliding_block__glu_gated_swiglu__prompt'

def setup_inputs():

    _w = (lambda a: (lambda t: t.to(torch.bfloat16) if t.is_floating_point() else t)(torch.as_tensor(a)))
    def _A_setup():
        B, S, D = 1, 2048, 512
        return {
            "x": _w((lambda *s: torch.randn(*s, dtype=torch.bfloat16) * 0.05)(B, S, D)),
            "wqkv": _w((lambda *s: torch.randn(*s, dtype=torch.bfloat16) * 0.05)(D, 3 * D)),
            "wo": _w((lambda *s: torch.randn(*s, dtype=torch.bfloat16) * 0.05)(D, D)),
        }
    _A_in = _A_setup()

    def _B_setup():
        B, S, D, F = 1, 2048, 512, 1376
        return {
            "x": _w((lambda *s: torch.randn(*s, dtype=torch.bfloat16) * 0.05)(B, S, D)),
            "w1": _w((lambda *s: torch.randn(*s, dtype=torch.bfloat16) * 0.8)(D, F) * (2.0 / D) ** 0.5),
            "w3": _w((lambda *s: torch.randn(*s, dtype=torch.bfloat16) * 0.8)(D, F) * (2.0 / D) ** 0.5),
            "w2": _w((lambda *s: torch.randn(*s, dtype=torch.bfloat16) * 0.8)(F, D) * (2.0 / F) ** 0.5),
        }
    _B_in = _B_setup()

    return {
        "A_x": _A_in["x"],
        "A_wqkv": _A_in["wqkv"],
        "A_wo": _A_in["wo"],
        "B_x": _B_in["x"],
        "B_w1": _B_in["w1"],
        "B_w3": _B_in["w3"],
        "B_w2": _B_in["w2"],
    }

def reference(A_x, A_wqkv, A_wo, B_x, B_w1, B_w3, B_w2):
    def _A_ref(x, wqkv, wo):
        B, S, D = x.shape
        H = 32; Dh = D // H; W = 256
        qkv = (lambda x, *d: x.permute(*d))((x @ wqkv).reshape(B, S, 3, H, Dh), 2, 0, 3, 1, 4)
        q, k, v = qkv[0], qkv[1], qkv[2]
        scores = torch.einsum("bhqd,bhkd->bhqk", q, k) * (Dh ** -0.5)
        idx = torch.arange(S)
        mask = (idx[:, None] - idx[None, :] >= 0) & (idx[:, None] - idx[None, :] < W)
        scores = torch.where(mask[None, None], scores, -1e9)
        p = _softmax(scores, axis=-1)
        o = torch.einsum("bhqk,bhkd->bhqd", p, v)
        return (lambda x, *d: x.permute(*d))(o, 0, 2, 1, 3).reshape(B, S, D) @ wo

    def _B_ref(x, w1, w3, w2):
        gate = torch.einsum("bsd,df->bsf", x, w1)
        up = torch.einsum("bsd,df->bsf", x, w3)
        h = _silu(gate) * up
        out = torch.einsum("bsf,fd->bsd", h, w2)
        return out

    x = A_x
    x = x + _A_ref(_layernorm(x, axis=-1), A_wqkv, A_wo)
    x = x + _B_ref(_layernorm(x, axis=-1), B_w1, B_w3, B_w2)
    x = x + _A_ref(_layernorm(x, axis=-1), A_wqkv, A_wo)
    x = x + _B_ref(_layernorm(x, axis=-1), B_w1, B_w3, B_w2)
    return x
```

```asm
; @launch grid=(256,1,1) block=(512,1,1) lds=163840
.amdgcn_target "amdgcn-amd-amdhsa--gfx950"
.text
.globl interleave_layers__sliding_block__glu_gated_swiglu__prompt_kernel
.p2align 8
.type interleave_layers__sliding_block__glu_gated_swiglu__prompt_kernel,@function
interleave_layers__sliding_block__glu_gated_swiglu__prompt_kernel:
  s_cmp_ge_u32 s2, 256
  s_cbranch_scc1 L_end
  s_load_dwordx2 s[4:5], s[0:1], 72
  s_load_dwordx4 s[16:19], s[0:1], 0
  s_load_dwordx2 s[20:21], s[0:1], 16
  s_load_dwordx4 s[24:27], s[0:1], 32
  s_load_dwordx2 s[28:29], s[0:1], 48
  s_load_dwordx2 s[6:7], s[0:1], 56
  v_lshrrev_b32 v1, 6, v0
  v_and_b32 v0, 63, v0
  v_readfirstlane_b32 s3, v1
  v_lshlrev_b32 v1, 4, v0
  v_lshrrev_b32 v2, 5, v0
  v_mov_b32 v3, 0x3f803f80
  s_mov_b32 s15, 0x20000
  s_mov_b32 s44, 999
  s_mov_b32 s45, 131072
  s_add_u32 s46, s2, 224
  s_add_u32 s47, s2, 480
  s_cmp_lt_u32 s2, 224
  s_cselect_b32 s48, s2, 999
  s_cmp_eq_u32 s3, 0
  s_cselect_b32 s44, s48, s44
  s_cmp_lt_u32 s2, 128
  s_cselect_b32 s48, s2, s44
  s_cmp_lt_u32 s3, 4
  s_cselect_b32 s44, s48, s44
  s_cmp_eq_u32 s3, 4
  s_cselect_b32 s44, s46, s44
  s_cselect_b32 s45, 98304, s45
  s_cmp_eq_u32 s3, 5
  s_cselect_b32 s44, s47, s44
  s_cselect_b32 s45, 114688, s45
  s_waitcnt lgkmcnt(0)
  s_add_u32 s46, s4, 0x4720000
  s_addc_u32 s47, s5, 0
  s_load_dword s99, s[46:47], 0
  s_mov_b32 s8, s4
  s_mov_b32 s9, s5
  s_mov_b32 s10, 0x5000000
  s_mov_b32 s11, 0x20000
  s_cmp_ge_u32 s44, 520
  s_cbranch_scc1 L_prep_none
  s_cmp_lt_u32 s44, 128
  s_cbranch_scc1 L_prep_x
L_prep_w:
  v_mov_b32 v10, v1
  v_mov_b32 v11, v1
  s_cmp_ge_u32 s44, 224
  s_cbranch_scc1 L_prep_w1
  s_sub_u32 s30, s44, 128
  s_and_b32 s31, s30, 3
  s_lshr_b32 s32, s30, 2
  s_mov_b32 s12, s18
  s_mov_b32 s13, s19
  s_mov_b32 s14, 1572864
  s_mov_b32 s33, 3072
  s_mul_i32 s35, s32, 65536
  s_lshl_b32 s36, s31, 13
  s_add_u32 s35, s35, s36
  s_add_u32 s35, s35, 0x4000000
  s_mov_b32 s38, 32768
  s_mul_i32 s39, s32, 2048
  s_lshr_b32 s36, s31, 1
  s_lshl_b32 s36, s36, 3
  s_add_u32 s39, s39, s36
  s_add_u32 s39, s39, 0x4680000
  s_mov_b32 s40, 1024
L_prep_wgo:
  v_lshrrev_b32 v4, 3, v0
  v_mul_lo_u32 v4, v4, s33
  v_and_b32 v5, 7, v0
  v_lshl_add_u32 v4, v5, 4, v4
  s_lshl_b32 s34, s31, 7
  s_mul_i32 s34, s34, s33
  s_lshl_b32 s36, s32, 7
  s_add_u32 s34, s34, s36
  s_lshl_b32 s36, s33, 3
  s_cmp_lt_u32 s3, 4
  s_cbranch_scc1 L_prep_b0
  s_barrier
L_prep_b0:
  s_add_u32 m0, s45, 0
  s_nop 0
  buffer_load_dwordx4 v4, s[12:15], s34 offen lds
  s_add_u32 s34, s34, s36
  s_add_u32 m0, s45, 1024
  s_nop 0
  buffer_load_dwordx4 v4, s[12:15], s34 offen lds
  s_add_u32 s34, s34, s36
  s_add_u32 m0, s45, 2048
  s_nop 0
  buffer_load_dwordx4 v4, s[12:15], s34 offen lds
  s_add_u32 s34, s34, s36
  s_add_u32 m0, s45, 3072
  s_nop 0
  buffer_load_dwordx4 v4, s[12:15], s34 offen lds
  s_add_u32 s34, s34, s36
  s_add_u32 m0, s45, 4096
  s_nop 0
  buffer_load_dwordx4 v4, s[12:15], s34 offen lds
  s_add_u32 s34, s34, s36
  s_add_u32 m0, s45, 5120
  s_nop 0
  buffer_load_dwordx4 v4, s[12:15], s34 offen lds
  s_add_u32 s34, s34, s36
  s_add_u32 m0, s45, 6144
  s_nop 0
  buffer_load_dwordx4 v4, s[12:15], s34 offen lds
  s_add_u32 s34, s34, s36
  s_add_u32 m0, s45, 7168
  s_nop 0
  buffer_load_dwordx4 v4, s[12:15], s34 offen lds
  s_add_u32 s34, s34, s36
  s_add_u32 m0, s45, 8192
  s_nop 0
  buffer_load_dwordx4 v4, s[12:15], s34 offen lds
  s_add_u32 s34, s34, s36
  s_add_u32 m0, s45, 9216
  s_nop 0
  buffer_load_dwordx4 v4, s[12:15], s34 offen lds
  s_add_u32 s34, s34, s36
  s_add_u32 m0, s45, 10240
  s_nop 0
  buffer_load_dwordx4 v4, s[12:15], s34 offen lds
  s_add_u32 s34, s34, s36
  s_add_u32 m0, s45, 11264
  s_nop 0
  buffer_load_dwordx4 v4, s[12:15], s34 offen lds
  s_add_u32 s34, s34, s36
  s_add_u32 m0, s45, 12288
  s_nop 0
  buffer_load_dwordx4 v4, s[12:15], s34 offen lds
  s_add_u32 s34, s34, s36
  s_add_u32 m0, s45, 13312
  s_nop 0
  buffer_load_dwordx4 v4, s[12:15], s34 offen lds
  s_add_u32 s34, s34, s36
  s_add_u32 m0, s45, 14336
  s_nop 0
  buffer_load_dwordx4 v4, s[12:15], s34 offen lds
  s_add_u32 s34, s34, s36
  s_add_u32 m0, s45, 15360
  s_nop 0
  buffer_load_dwordx4 v4, s[12:15], s34 offen lds
  s_add_u32 s34, s34, s36
  s_mov_b32 s50, 0
  s_mov_b32 s51, 2048
  s_mov_b32 s52, 4096
  s_mov_b32 s53, 6144
  s_cmp_lt_u32 s44, 432
  s_cbranch_scc1 L_prep_np
  s_lshl_b32 s36, s31, 13
  s_sub_u32 s35, s35, s36
  s_lshl_b32 s54, s31, 2
  s_add_u32 s54, s54, 0
  s_mul_hi_u32 s55, s54, 0x55555556
  s_mul_i32 s56, s55, 3
  s_sub_u32 s56, s54, s56
  s_lshl_b32 s57, s56, 4
  s_min_u32 s57, s57, 30
  s_add_u32 s57, s57, s55
  s_cmp_eq_u32 s54, 43
  s_cselect_b32 s57, 15, s57
  s_lshl_b32 s50, s57, 11
  s_lshl_b32 s54, s31, 2
  s_add_u32 s54, s54, 1
  s_mul_hi_u32 s55, s54, 0x55555556
  s_mul_i32 s56, s55, 3
  s_sub_u32 s56, s54, s56
  s_lshl_b32 s57, s56, 4
  s_min_u32 s57, s57, 30
  s_add_u32 s57, s57, s55
  s_cmp_eq_u32 s54, 43
  s_cselect_b32 s57, 15, s57
  s_lshl_b32 s51, s57, 11
  s_lshl_b32 s54, s31, 2
  s_add_u32 s54, s54, 2
  s_mul_hi_u32 s55, s54, 0x55555556
  s_mul_i32 s56, s55, 3
  s_sub_u32 s56, s54, s56
  s_lshl_b32 s57, s56, 4
  s_min_u32 s57, s57, 30
  s_add_u32 s57, s57, s55
  s_cmp_eq_u32 s54, 43
  s_cselect_b32 s57, 15, s57
  s_lshl_b32 s52, s57, 11
  s_lshl_b32 s54, s31, 2
  s_add_u32 s54, s54, 3
  s_mul_hi_u32 s55, s54, 0x55555556
  s_mul_i32 s56, s55, 3
  s_sub_u32 s56, s54, s56
  s_lshl_b32 s57, s56, 4
  s_min_u32 s57, s57, 30
  s_add_u32 s57, s57, s55
  s_cmp_eq_u32 s54, 43
  s_cselect_b32 s57, 15, s57
  s_lshl_b32 s53, s57, 11
L_prep_np:
  v_bfe_u32 v5, v0, 2, 2
  v_lshl_add_u32 v5, v2, 2, v5
  v_lshlrev_b32 v5, 7, v5
  v_bfe_u32 v6, v0, 4, 1
  v_lshl_add_u32 v5, v6, 5, v5
  v_and_b32 v6, 3, v0
  v_lshl_add_u32 v5, v6, 3, v5
  v_add_u32 v5, s45, v5
  s_waitcnt vmcnt(0) lgkmcnt(0)
  s_add_u32 s98, s99, 0x9e3779b1
  ds_read_b64_tr_b16 v[16:17], v5 offset:0
  ds_read_b64_tr_b16 v[18:19], v5 offset:1024
  ds_read_b64_tr_b16 v[20:21], v5 offset:2048
  ds_read_b64_tr_b16 v[22:23], v5 offset:3072
  ds_read_b64_tr_b16 v[24:25], v5 offset:4096
  ds_read_b64_tr_b16 v[26:27], v5 offset:5120
  ds_read_b64_tr_b16 v[28:29], v5 offset:6144
  ds_read_b64_tr_b16 v[30:31], v5 offset:7168
  ds_read_b64_tr_b16 v[32:33], v5 offset:8192
  ds_read_b64_tr_b16 v[34:35], v5 offset:9216
  ds_read_b64_tr_b16 v[36:37], v5 offset:10240
  ds_read_b64_tr_b16 v[38:39], v5 offset:11264
  ds_read_b64_tr_b16 v[40:41], v5 offset:12288
  ds_read_b64_tr_b16 v[42:43], v5 offset:13312
  ds_read_b64_tr_b16 v[44:45], v5 offset:14336
  ds_read_b64_tr_b16 v[46:47], v5 offset:15360
  s_waitcnt lgkmcnt(0)
  s_add_u32 s41, s35, s50
  buffer_store_dwordx4 v[16:19], v10, s[8:11], s41 offen offset:0 sc1
  buffer_store_dwordx4 v[20:23], v10, s[8:11], s41 offen offset:1024 sc1
  s_add_u32 s41, s35, s51
  buffer_store_dwordx4 v[24:27], v10, s[8:11], s41 offen offset:0 sc1
  buffer_store_dwordx4 v[28:31], v10, s[8:11], s41 offen offset:1024 sc1
  s_add_u32 s41, s35, s52
  buffer_store_dwordx4 v[32:35], v10, s[8:11], s41 offen offset:0 sc1
  buffer_store_dwordx4 v[36:39], v10, s[8:11], s41 offen offset:1024 sc1
  s_add_u32 s41, s35, s53
  buffer_store_dwordx4 v[40:43], v10, s[8:11], s41 offen offset:0 sc1
  buffer_store_dwordx4 v[44:47], v10, s[8:11], s41 offen offset:1024 sc1
  s_add_u32 s35, s35, s38
  ds_read_b64_tr_b16 v[48:49], v5 offset:64
  ds_read_b64_tr_b16 v[50:51], v5 offset:1088
  ds_read_b64_tr_b16 v[52:53], v5 offset:2112
  ds_read_b64_tr_b16 v[54:55], v5 offset:3136
  ds_read_b64_tr_b16 v[56:57], v5 offset:4160
  ds_read_b64_tr_b16 v[58:59], v5 offset:5184
  ds_read_b64_tr_b16 v[60:61], v5 offset:6208
  ds_read_b64_tr_b16 v[62:63], v5 offset:7232
  ds_read_b64_tr_b16 v[64:65], v5 offset:8256
  ds_read_b64_tr_b16 v[66:67], v5 offset:9280
  ds_read_b64_tr_b16 v[68:69], v5 offset:10304
  ds_read_b64_tr_b16 v[70:71], v5 offset:11328
  ds_read_b64_tr_b16 v[72:73], v5 offset:12352
  ds_read_b64_tr_b16 v[74:75], v5 offset:13376
  ds_read_b64_tr_b16 v[76:77], v5 offset:14400
  ds_read_b64_tr_b16 v[78:79], v5 offset:15424
  s_waitcnt lgkmcnt(0)
  s_add_u32 s41, s35, s50
  buffer_store_dwordx4 v[48:51], v10, s[8:11], s41 offen offset:0 sc1
  buffer_store_dwordx4 v[52:55], v10, s[8:11], s41 offen offset:1024 sc1
  s_add_u32 s41, s35, s51
  buffer_store_dwordx4 v[56:59], v10, s[8:11], s41 offen offset:0 sc1
  buffer_store_dwordx4 v[60:63], v10, s[8:11], s41 offen offset:1024 sc1
  s_add_u32 s41, s35, s52
  buffer_store_dwordx4 v[64:67], v10, s[8:11], s41 offen offset:0 sc1
  buffer_store_dwordx4 v[68:71], v10, s[8:11], s41 offen offset:1024 sc1
  s_add_u32 s41, s35, s53
  buffer_store_dwordx4 v[72:75], v10, s[8:11], s41 offen offset:0 sc1
  buffer_store_dwordx4 v[76:79], v10, s[8:11], s41 offen offset:1024 sc1
  s_add_u32 s35, s35, s38
  s_cmp_eq_u32 s39, 0
  s_cbranch_scc1 L_prep_wend
  s_and_b32 s36, s31, 1
  v_cmp_eq_u32 vcc, s36, v2
  v_mov_b32 v80, 0
  v_mov_b32 v81, 0
  v_dot2c_f32_bf16 v80, v16, v3
  v_dot2c_f32_bf16 v81, v17, v3
  v_dot2c_f32_bf16 v80, v18, v3
  v_dot2c_f32_bf16 v81, v19, v3
  v_dot2c_f32_bf16 v80, v20, v3
  v_dot2c_f32_bf16 v81, v21, v3
  v_dot2c_f32_bf16 v80, v22, v3
  v_dot2c_f32_bf16 v81, v23, v3
  v_dot2c_f32_bf16 v80, v24, v3
  v_dot2c_f32_bf16 v81, v25, v3
  v_dot2c_f32_bf16 v80, v26, v3
  v_dot2c_f32_bf16 v81, v27, v3
  v_dot2c_f32_bf16 v80, v28, v3
  v_dot2c_f32_bf16 v81, v29, v3
  v_dot2c_f32_bf16 v80, v30, v3
  v_dot2c_f32_bf16 v81, v31, v3
  v_dot2c_f32_bf16 v80, v32, v3
  v_dot2c_f32_bf16 v81, v33, v3
  v_dot2c_f32_bf16 v80, v34, v3
  v_dot2c_f32_bf16 v81, v35, v3
  v_dot2c_f32_bf16 v80, v36, v3
  v_dot2c_f32_bf16 v81, v37, v3
  v_dot2c_f32_bf16 v80, v38, v3
  v_dot2c_f32_bf16 v81, v39, v3
  v_dot2c_f32_bf16 v80, v40, v3
  v_dot2c_f32_bf16 v81, v41, v3
  v_dot2c_f32_bf16 v80, v42, v3
  v_dot2c_f32_bf16 v81, v43, v3
  v_dot2c_f32_bf16 v80, v44, v3
  v_dot2c_f32_bf16 v81, v45, v3
  v_dot2c_f32_bf16 v80, v46, v3
  v_dot2c_f32_bf16 v81, v47, v3
  s_nop 3
  v_add_f32 v80, v80, v81
  v_mov_b32 v81, v80
  s_nop 1
  v_permlane32_swap_b32 v80, v81
  s_nop 1
  v_add_f32 v80, v80, v81
  v_cvt_pk_bf16_f32 v84, v80, v80
  v_and_b32 v82, 0xffff0000, v84
  v_sub_f32 v82, v80, v82
  v_cvt_pk_bf16_f32 v85, v82, v82
  v_mov_b32 v80, 0
  v_mov_b32 v81, 0
  v_dot2c_f32_bf16 v80, v48, v3
  v_dot2c_f32_bf16 v81, v49, v3
  v_dot2c_f32_bf16 v80, v50, v3
  v_dot2c_f32_bf16 v81, v51, v3
  v_dot2c_f32_bf16 v80, v52, v3
  v_dot2c_f32_bf16 v81, v53, v3
  v_dot2c_f32_bf16 v80, v54, v3
  v_dot2c_f32_bf16 v81, v55, v3
  v_dot2c_f32_bf16 v80, v56, v3
  v_dot2c_f32_bf16 v81, v57, v3
  v_dot2c_f32_bf16 v80, v58, v3
  v_dot2c_f32_bf16 v81, v59, v3
  v_dot2c_f32_bf16 v80, v60, v3
  v_dot2c_f32_bf16 v81, v61, v3
  v_dot2c_f32_bf16 v80, v62, v3
  v_dot2c_f32_bf16 v81, v63, v3
  v_dot2c_f32_bf16 v80, v64, v3
  v_dot2c_f32_bf16 v81, v65, v3
  v_dot2c_f32_bf16 v80, v66, v3
  v_dot2c_f32_bf16 v81, v67, v3
  v_dot2c_f32_bf16 v80, v68, v3
  v_dot2c_f32_bf16 v81, v69, v3
  v_dot2c_f32_bf16 v80, v70, v3
  v_dot2c_f32_bf16 v81, v71, v3
  v_dot2c_f32_bf16 v80, v72, v3
  v_dot2c_f32_bf16 v81, v73, v3
  v_dot2c_f32_bf16 v80, v74, v3
  v_dot2c_f32_bf16 v81, v75, v3
  v_dot2c_f32_bf16 v80, v76, v3
  v_dot2c_f32_bf16 v81, v77, v3
  v_dot2c_f32_bf16 v80, v78, v3
  v_dot2c_f32_bf16 v81, v79, v3
  s_nop 3
  v_add_f32 v80, v80, v81
  v_mov_b32 v81, v80
  s_nop 1
  v_permlane32_swap_b32 v80, v81
  s_nop 1
  v_add_f32 v80, v80, v81
  v_cvt_pk_bf16_f32 v86, v80, v80
  v_and_b32 v82, 0xffff0000, v86
  v_sub_f32 v82, v80, v82
  v_cvt_pk_bf16_f32 v87, v82, v82
  s_and_saveexec_b64 s[42:43], vcc
  buffer_store_dwordx2 v[84:85], v11, s[8:11], s39 offen sc1
  s_add_u32 s39, s39, s40
  buffer_store_dwordx2 v[86:87], v11, s[8:11], s39 offen sc1
  s_mov_b64 exec, -1
L_prep_wend:
  s_sub_u32 s34, s44, 128
  s_lshl_b32 s34, s34, 7
  s_add_u32 s34, s34, 0x4700000
  v_mov_b32 v8, 0
  v_mov_b32 v9, s98
  s_barrier
  s_waitcnt vmcnt(0)
  s_mov_b64 exec, 1
  buffer_store_dword v9, v8, s[8:11], s34 offen sc1
  s_mov_b64 exec, -1
  s_branch L_prep_done
L_prep_w1:
  s_cmp_ge_u32 s44, 312
  s_cbranch_scc1 L_prep_w3
  s_sub_u32 s30, s44, 224
  s_and_b32 s31, s30, 3
  s_lshr_b32 s32, s30, 2
  s_mov_b32 s12, s24
  s_mov_b32 s13, s25
  s_mov_b32 s14, 1409024
  s_mov_b32 s33, 2752
  s_mul_i32 s35, s32, 131072
  s_lshl_b32 s36, s31, 13
  s_add_u32 s35, s35, s36
  s_add_u32 s35, s35, 0x4200000
  s_mov_b32 s38, 65536
  s_mul_i32 s39, s32, 4096
  s_lshr_b32 s36, s31, 1
  s_lshl_b32 s36, s36, 3
  s_add_u32 s39, s39, s36
  s_add_u32 s39, s39, 0x4690000
  s_mov_b32 s40, 2048
  v_and_b32 v4, 15, v0
  v_lshl_add_u32 v4, v2, 5, v4
  v_add_u32 v4, 0, v4
  v_lshlrev_b32 v4, 4, v4
  v_bfe_u32 v5, v0, 4, 1
  v_lshl_add_u32 v10, v5, 15, v4
  v_lshl_add_u32 v11, v5, 10, v4
  s_branch L_prep_wgo
L_prep_w3:
  s_cmp_ge_u32 s44, 400
  s_cbranch_scc1 L_prep_wo
  s_sub_u32 s30, s44, 312
  s_and_b32 s31, s30, 3
  s_lshr_b32 s32, s30, 2
  s_mov_b32 s12, s26
  s_mov_b32 s13, s27
  s_mov_b32 s14, 1409024
  s_mov_b32 s33, 2752
  s_mul_i32 s35, s32, 131072
  s_lshl_b32 s36, s31, 13
  s_add_u32 s35, s35, s36
  s_add_u32 s35, s35, 0x4200000
  s_mov_b32 s38, 65536
  s_mul_i32 s39, s32, 4096
  s_lshr_b32 s36, s31, 1
  s_lshl_b32 s36, s36, 3
  s_add_u32 s39, s39, s36
  s_add_u32 s39, s39, 0x4690000
  s_mov_b32 s40, 2048
  v_and_b32 v4, 15, v0
  v_lshl_add_u32 v4, v2, 5, v4
  v_add_u32 v4, 16, v4
  v_lshlrev_b32 v4, 4, v4
  v_bfe_u32 v5, v0, 4, 1
  v_lshl_add_u32 v10, v5, 15, v4
  v_lshl_add_u32 v11, v5, 10, v4
  s_branch L_prep_wgo
L_prep_wo:
  s_cmp_ge_u32 s44, 432
  s_cbranch_scc1 L_prep_w2
  s_sub_u32 s30, s44, 400
  s_and_b32 s31, s30, 3
  s_lshr_b32 s32, s30, 2
  s_mov_b32 s12, s20
  s_mov_b32 s13, s21
  s_mov_b32 s14, 524288
  s_mov_b32 s33, 1024
  s_mul_i32 s35, s32, 65536
  s_lshl_b32 s36, s31, 13
  s_add_u32 s35, s35, s36
  s_add_u32 s35, s35, 0x4180000
  s_mov_b32 s38, 32768
  s_mov_b32 s39, 0
  s_mov_b32 s40, 0
  s_branch L_prep_wgo
L_prep_w2:
  s_sub_u32 s30, s44, 432
  s_and_b32 s32, s30, 7
  s_lshr_b32 s31, s30, 3
  s_mov_b32 s12, s28
  s_mov_b32 s13, s29
  s_mov_b32 s14, 1409024
  s_mov_b32 s33, 1024
  s_mul_i32 s35, s32, 180224
  s_lshl_b32 s36, s31, 13
  s_add_u32 s35, s35, s36
  s_add_u32 s35, s35, 0x4500000
  s_mov_b32 s38, 90112
  s_mov_b32 s39, 0
  s_mov_b32 s40, 0
  s_branch L_prep_wgo
L_prep_x:
  s_mov_b32 s12, s16
  s_mov_b32 s13, s17
  s_mov_b32 s14, 0x200000
  s_lshr_b32 s30, s44, 1
  s_and_b32 s31, s44, 1
  s_lshl_b32 s31, s31, 2
  s_add_u32 s31, s31, s3
  s_lshl_b32 s32, s30, 15
  s_lshl_b32 s33, s31, 7
  s_add_u32 s32, s32, s33
  s_mul_i32 s33, s3, 4160
  s_add_u32 s45, s45, s33
  v_lshrrev_b32 v5, 3, v0
  v_lshlrev_b32 v5, 12, v5
  v_and_b32 v6, 7, v0
  v_lshl_add_u32 v5, v6, 4, v5
  s_add_u32 s34, s32, 0
  s_add_u32 m0, s45, 0
  s_nop 0
  buffer_load_dwordx4 v5, s[12:15], s34 offen lds
  s_add_u32 s34, s32, 1024
  s_add_u32 m0, s45, 1040
  s_nop 0
  buffer_load_dwordx4 v5, s[12:15], s34 offen lds
  s_add_u32 s34, s32, 2048
  s_add_u32 m0, s45, 2080
  s_nop 0
  buffer_load_dwordx4 v5, s[12:15], s34 offen lds
  s_add_u32 s34, s32, 3072
  s_add_u32 m0, s45, 3120
  s_nop 0
  buffer_load_dwordx4 v5, s[12:15], s34 offen lds
  v_and_b32 v6, 3, v0
  v_mul_u32_u24 v6, 1040, v6
  v_bfe_u32 v7, v0, 2, 3
  v_lshlrev_b32 v7, 7, v7
  v_add_u32 v6, v6, v7
  v_lshlrev_b32 v7, 3, v2
  v_add3_u32 v6, v6, v7, s45
  s_lshl_b32 s35, s30, 15
  s_lshl_b32 s36, s31, 12
  s_add_u32 s35, s35, s36
  s_add_u32 s35, s35, 0x0
  s_lshl_b32 s37, s30, 12
  s_lshr_b32 s36, s31, 1
  s_lshl_b32 s36, s36, 10
  s_add_u32 s37, s37, s36
  s_and_b32 s36, s31, 1
  s_lshl_b32 s36, s36, 3
  s_add_u32 s37, s37, s36
  s_add_u32 s37, s37, 0xf80000
  v_lshlrev_b32 v7, 2, v0
  v_mov_b32 v80, 0
  v_mov_b32 v81, 0
  v_mov_b32 v82, 0
  v_mov_b32 v83, 0
  s_waitcnt vmcnt(0) lgkmcnt(0)
  s_add_u32 s98, s99, 0x9e3779b1
  ds_read2_b64 v[16:19], v6 offset0:0 offset1:2
  ds_read2_b64 v[20:23], v6 offset0:4 offset1:6
  ds_read2_b64 v[24:27], v6 offset0:8 offset1:10
  ds_read2_b64 v[28:31], v6 offset0:12 offset1:14
  s_waitcnt lgkmcnt(3)
  buffer_store_dwordx4 v[16:19], v1, s[8:11], s35 offen offset:0 sc1
  s_waitcnt lgkmcnt(2)
  buffer_store_dwordx4 v[20:23], v1, s[8:11], s35 offen offset:1024 sc1
  s_waitcnt lgkmcnt(1)
  buffer_store_dwordx4 v[24:27], v1, s[8:11], s35 offen offset:2048 sc1
  s_waitcnt lgkmcnt(0)
  buffer_store_dwordx4 v[28:31], v1, s[8:11], s35 offen offset:3072 sc1
  v_dot2c_f32_bf16 v80, v16, v3
  v_dot2c_f32_bf16 v81, v16, v16
  v_dot2c_f32_bf16 v82, v24, v3
  v_dot2c_f32_bf16 v83, v24, v24
  v_dot2c_f32_bf16 v80, v17, v3
  v_dot2c_f32_bf16 v81, v17, v17
  v_dot2c_f32_bf16 v82, v25, v3
  v_dot2c_f32_bf16 v83, v25, v25
  v_dot2c_f32_bf16 v80, v18, v3
  v_dot2c_f32_bf16 v81, v18, v18
  v_dot2c_f32_bf16 v82, v26, v3
  v_dot2c_f32_bf16 v83, v26, v26
  v_dot2c_f32_bf16 v80, v19, v3
  v_dot2c_f32_bf16 v81, v19, v19
  v_dot2c_f32_bf16 v82, v27, v3
  v_dot2c_f32_bf16 v83, v27, v27
  v_dot2c_f32_bf16 v80, v20, v3
  v_dot2c_f32_bf16 v81, v20, v20
  v_dot2c_f32_bf16 v82, v28, v3
  v_dot2c_f32_bf16 v83, v28, v28
  v_dot2c_f32_bf16 v80, v21, v3
  v_dot2c_f32_bf16 v81, v21, v21
  v_dot2c_f32_bf16 v82, v29, v3
  v_dot2c_f32_bf16 v83, v29, v29
  v_dot2c_f32_bf16 v80, v22, v3
  v_dot2c_f32_bf16 v81, v22, v22
  v_dot2c_f32_bf16 v82, v30, v3
  v_dot2c_f32_bf16 v83, v30, v30
  v_dot2c_f32_bf16 v80, v23, v3
  v_dot2c_f32_bf16 v81, v23, v23
  v_dot2c_f32_bf16 v82, v31, v3
  v_dot2c_f32_bf16 v83, v31, v31
  s_nop 3
  v_permlane32_swap_b32 v80, v81
  v_permlane32_swap_b32 v82, v83
  s_nop 1
  v_add_f32 v80, v80, v81
  v_add_f32 v81, v82, v83
  buffer_store_dwordx2 v[80:81], v1, s[8:11], s37 offen sc1
  s_lshl_b32 s34, s30, 11
  s_lshl_b32 s36, s31, 3
  s_add_u32 s34, s34, s36
  s_add_u32 s34, s34, 0x1000000
  v_lshlrev_b32 v8, 2, v0
  v_mov_b32 v9, s98
  s_barrier
  s_waitcnt vmcnt(0)
  s_mov_b64 exec, 3
  buffer_store_dword v9, v8, s[8:11], s34 offen sc1
  s_mov_b64 exec, -1
  s_branch L_prep_done
L_prep_none:
  s_waitcnt lgkmcnt(0)
  s_add_u32 s98, s99, 0x9e3779b1
  s_cmp_lg_u32 s3, 6
  s_cbranch_scc1 L_noxid
  s_and_b32 s46, s2, 15
  s_lshl_b32 s46, s46, 4
  s_lshr_b32 s47, s2, 4
  s_add_u32 s46, s46, s47
  s_lshl_b32 s46, s46, 7
  s_add_u32 s46, s46, 0x4730000
  s_getreg_b32 s47, hwreg(HW_REG_XCC_ID, 0, 4)
  s_add_u32 s47, s47, s98
  v_mov_b32 v7, s47
  v_mov_b32 v8, 0
  s_mov_b64 exec, 1
  buffer_store_dword v7, v8, s[8:11], s46 offen sc1
  s_mov_b64 exec, -1
L_noxid:
  s_cmp_lg_u32 s3, 7
  s_cbranch_scc1 L_nocw
  s_getpc_b64 s[46:47]
L_pc:
  s_lshr_b32 s48, s2, 3
  s_and_b32 s48, s48, 7
  s_mul_i32 s48, s48, 3456
  v_min_u32 v6, 26, v0
  v_lshlrev_b32 v6, 7, v6
  v_add_u32 v6, s48, v6
  v_min_u32 v6, L_end-L_pc, v6
  global_load_dword v14, v6, s[46:47]
L_nocw:
  s_barrier
  s_cmp_lt_u32 s3, 4
  s_cbranch_scc1 L_prep_done
  s_barrier
  s_branch L_prep_done
L_prep_done:
  v_lshlrev_b32 v2, 2, v0
  s_cmp_lg_u32 s3, 1
  s_cbranch_scc1 L_nocnt
  s_load_dwordx2 s[28:29], s[0:1], 64
  s_waitcnt lgkmcnt(0)
  s_mov_b32 s30, 256
  s_mov_b32 s31, 0x20000
  v_mov_b32 v7, 1
  v_mov_b32 v8, 0
  s_mov_b64 exec, 1
  buffer_atomic_add v7, v8, s[28:31], 0 offen sc1
  s_mov_b64 exec, -1
L_nocnt:
  s_and_b32 s16, s2, 7
  s_lshl_b32 s16, s16, 1
  s_bfe_u32 s17, s2, 0x10003
  s_add_u32 s16, s16, s17
  s_lshr_b32 s17, s2, 4
  s_mov_b32 s101, 0
  s_and_b32 s18, s3, 3
  s_lshl_b32 s19, s16, 2
  s_add_u32 s19, s19, s18
  s_mov_b32 s20, 0
  s_lshl_b32 s22, s18, 12
  v_add_u32 v4, 61440, v1
  v_add_u32 v5, 122880, v1
  s_and_b32 s28, s18, 1
  s_lshr_b32 s29, s18, 1
  s_lshl_b32 s29, s29, 12
  s_lshl_b32 s23, s28, 4
  s_add_u32 s23, s23, s17
  s_add_u32 s23, s23, 16
  s_lshl_b32 s23, s23, 15
  s_add_u32 s23, s23, 0x4000000
  s_and_b32 s100, s17, 7
  s_lshl_b32 s100, s100, 12
  s_mul_i32 s100, s100, 0
  s_add_u32 s99, s100, s29
  s_lshl_b32 s24, s17, 15
  s_add_u32 s24, s24, 0x4000000
  s_and_b32 s30, s17, 14
  s_add_u32 s30, s30, s28
  s_lshl_b32 s25, s30, 15
  s_add_u32 s25, s25, s29
  s_add_u32 s25, s25, 0x4180000
  s_mul_i32 s27, s30, 90112
  s_add_u32 s27, s27, s29
  s_add_u32 s27, s27, 0x4500000
  s_mul_i32 s21, s17, 6
  s_add_u32 s26, s21, s28
  s_lshl_b32 s26, s26, 15
  s_add_u32 s26, s26, 0x4200000
  s_cmp_eq_u32 s17, 15
  s_cselect_b32 s26, 0x40000000, s26
  v_lshrrev_b32 v6, 5, v0
  v_lshlrev_b32 v6, 2, v6
  v_and_b32 v7, 31, v0
  v_sub_u32 v6, v6, v7
  v_cmp_lt_i32 s[32:33], 0, v6
  v_cmp_lt_i32 s[34:35], -1, v6
  v_cmp_lt_i32 s[36:37], -2, v6
  v_cmp_lt_i32 s[38:39], -3, v6
  v_cmp_lt_i32 s[40:41], -8, v6
  v_cmp_lt_i32 s[42:43], -9, v6
  v_cmp_lt_i32 s[44:45], -10, v6
  v_cmp_lt_i32 s[46:47], -11, v6
  v_cmp_lt_i32 s[48:49], -16, v6
  v_add_u32 v7, 17, v6
  v_cmp_lt_i32 s[50:51], 0, v7
  v_add_u32 v7, 18, v6
  v_cmp_lt_i32 s[52:53], 0, v7
  v_add_u32 v7, 19, v6
  v_cmp_lt_i32 s[54:55], 0, v7
  v_add_u32 v7, 24, v6
  v_cmp_lt_i32 s[56:57], 0, v7
  v_add_u32 v7, 25, v6
  v_cmp_lt_i32 s[58:59], 0, v7
  v_add_u32 v7, 26, v6
  v_cmp_lt_i32 s[60:61], 0, v7
  v_add_u32 v7, 27, v6
  v_cmp_lt_i32 s[62:63], 0, v7
  s_mov_b32 s12, s4
  s_mov_b32 s13, s5
  s_mov_b32 s14, 0x4000000
  s_mov_b32 s15, 0x20000
  s_and_b32 s92, s17, 1
  s_lshl_b32 s92, s92, 1
  s_lshr_b32 s93, s18, 1
  s_add_u32 s92, s92, s93
  s_lshl_b32 s93, s16, 2
  s_add_u32 s92, s92, s93
  s_and_b32 s93, s17, 14
  s_and_b32 s94, s18, 1
  s_add_u32 s93, s93, s94
  s_lshl_b32 s95, s92, 15
  s_lshl_b32 s28, s93, 11
  s_add_u32 s95, s95, s28
  s_cmp_ge_u32 s3, 4
  s_cbranch_scc1 L_Linit
  v_bfe_u32 v3, v0, 2, 2
  v_min_u32 v3, 2, v3
  v_lshlrev_b32 v3, 5, v3
  v_and_b32 v6, 3, v0
  v_add_u32 v3, v3, v6
  v_lshlrev_b32 v3, 7, v3
  s_lshr_b32 s28, s17, 1
  s_lshl_b32 s28, s28, 9
  s_add_u32 s28, s28, 0x4700000
  v_add_u32 v3, s28, v3
  v_and_b32 v6, 15, v0
  v_lshlrev_b32 v6, 2, v6
  s_lshl_b32 s29, s19, 11
  s_add_u32 s29, s29, 0x1000000
  v_add_u32 v6, s29, v6
  v_cmp_gt_u32 vcc, 32, v0
  s_mov_b32 s28, 0
  s_nop 0
  v_cndmask_b32 v3, v6, v3, vcc
  s_mov_b32 s31, 0
L_interleave_layers__sliding_block__glu_gated_swiglu__prompt_1:
  buffer_load_dword v6, v3, s[8:11], s28 offen sc1
  s_waitcnt vmcnt(0)
  v_cmp_eq_u32 vcc, s98, v6
  s_nop 1
  s_cmp_eq_u64 vcc, -1
  s_cbranch_scc1 L_interleave_layers__sliding_block__glu_gated_swiglu__prompt_2
  s_add_u32 s31, s31, 1
  s_cmp_lt_u32 s31, 0x20000
  s_cbranch_scc1 L_interleave_layers__sliding_block__glu_gated_swiglu__prompt_1
L_interleave_layers__sliding_block__glu_gated_swiglu__prompt_2:
  s_add_u32 m0, s22, 0
  s_add_u32 s30, s99, 0
  s_and_b32 s30, s30, 0x7fff
  s_add_u32 s30, s30, s23
  buffer_load_dwordx4 v1, s[8:11], s30 offen offset:0  lds
  buffer_load_dwordx4 v1, s[8:11], s30 offen offset:1024  lds
  buffer_load_dwordx4 v1, s[8:11], s30 offen offset:2048  lds
  buffer_load_dwordx4 v1, s[8:11], s30 offen offset:3072  lds
  s_add_u32 m0, s22, 16384
  s_add_u32 s30, s99, 8192
  s_and_b32 s30, s30, 0x7fff
  s_add_u32 s30, s30, s23
  buffer_load_dwordx4 v1, s[8:11], s30 offen offset:0  lds
  buffer_load_dwordx4 v1, s[8:11], s30 offen offset:1024  lds
  buffer_load_dwordx4 v1, s[8:11], s30 offen offset:2048  lds
  buffer_load_dwordx4 v1, s[8:11], s30 offen offset:3072  lds
  s_add_u32 m0, s22, 32768
  s_add_u32 s30, s99, 16384
  s_and_b32 s30, s30, 0x7fff
  s_add_u32 s30, s30, s23
  buffer_load_dwordx4 v1, s[8:11], s30 offen offset:0  lds
  buffer_load_dwordx4 v1, s[8:11], s30 offen offset:1024  lds
  buffer_load_dwordx4 v1, s[8:11], s30 offen offset:2048  lds
  buffer_load_dwordx4 v1, s[8:11], s30 offen offset:3072  lds
  s_add_u32 m0, s22, 49152
  s_add_u32 s30, s99, 24576
  s_and_b32 s30, s30, 0x7fff
  s_add_u32 s30, s30, s23
  buffer_load_dwordx4 v1, s[8:11], s30 offen offset:0  lds
  buffer_load_dwordx4 v1, s[8:11], s30 offen offset:1024  lds
  buffer_load_dwordx4 v1, s[8:11], s30 offen offset:2048  lds
  buffer_load_dwordx4 v1, s[8:11], s30 offen offset:3072  lds
L_Ctop:
  s_setprio 0
  s_lshl_b32 s28, s17, 10
  s_add_u32 s28, s28, 0x4680000
  buffer_load_dwordx4 v[80:83], v1, s[8:11], s28 offen
  s_add_u32 s28, s28, 16384
  buffer_load_dwordx4 v[84:87], v1, s[8:11], s28 offen
  s_add_u32 s28, s28, 16384
  buffer_load_dwordx4 v[88:91], v1, s[8:11], s28 offen
  v_and_b32 v3, 15, v0
  v_lshlrev_b32 v3, 2, v3
  s_lshl_b32 s29, s19, 11
  s_add_u32 s28, s29, 0x1000000
  s_cmp_eq_u32 s20, 0
  s_cbranch_scc1 L_Cnopoll
  s_mov_b32 s31, 0
L_interleave_layers__sliding_block__glu_gated_swiglu__prompt_3:
  buffer_load_dword v6, v3, s[12:15], s28 offen sc1
  s_waitcnt vmcnt(0)
  v_cmp_eq_u32 vcc, s98, v6
  s_nop 1
  s_cmp_eq_u64 vcc, -1
  s_cbranch_scc1 L_interleave_layers__sliding_block__glu_gated_swiglu__prompt_4
  s_add_u32 s31, s31, 1
  s_cmp_lt_u32 s31, 0x20000
  s_cbranch_scc1 L_interleave_layers__sliding_block__glu_gated_swiglu__prompt_3
L_interleave_layers__sliding_block__glu_gated_swiglu__prompt_4:
L_Cnopoll:
  s_lshl_b32 s90, s19, 15
  s_add_u32 s90, s90, 0x0
  s_lshl_b32 s29, s19, 12
  s_add_u32 s29, s29, 0xf80000
  buffer_load_dwordx4 v[96:99], v1, s[12:15], s29 offen offset:0 sc1
  buffer_load_dwordx4 v[100:103], v1, s[12:15], s29 offen offset:1024 sc1
  buffer_load_dwordx4 v[104:107], v1, s[12:15], s29 offen offset:2048 sc1
  buffer_load_dwordx4 v[108:111], v1, s[12:15], s29 offen offset:3072 sc1
  s_add_u32 s28, s90, 0
  buffer_load_dwordx4 v[128:131], v1, s[12:15], s28 offen offset:0 sc1
  buffer_load_dwordx4 v[132:135], v1, s[12:15], s28 offen offset:1024 sc1
  buffer_load_dwordx4 v[136:139], v1, s[12:15], s28 offen offset:2048 sc1
  buffer_load_dwordx4 v[140:143], v1, s[12:15], s28 offen offset:3072 sc1
  s_add_u32 s28, s90, 4096
  buffer_load_dwordx4 v[144:147], v1, s[12:15], s28 offen offset:0 sc1
  buffer_load_dwordx4 v[148:151], v1, s[12:15], s28 offen offset:1024 sc1
  buffer_load_dwordx4 v[152:155], v1, s[12:15], s28 offen offset:2048 sc1
  buffer_load_dwordx4 v[156:159], v1, s[12:15], s28 offen offset:3072 sc1
  s_waitcnt vmcnt(12)
  s_barrier
  s_add_u32 s28, s90, 8192
  buffer_load_dwordx4 v[160:163], v1, s[12:15], s28 offen offset:0 sc1
  buffer_load_dwordx4 v[164:167], v1, s[12:15], s28 offen offset:1024 sc1
  buffer_load_dwordx4 v[168:171], v1, s[12:15], s28 offen offset:2048 sc1
  buffer_load_dwordx4 v[172:175], v1, s[12:15], s28 offen offset:3072 sc1
  s_add_u32 s28, s90, 12288
  buffer_load_dwordx4 v[176:179], v1, s[12:15], s28 offen offset:0 sc1
  buffer_load_dwordx4 v[180:183], v1, s[12:15], s28 offen offset:1024 sc1
  buffer_load_dwordx4 v[184:187], v1, s[12:15], s28 offen offset:2048 sc1
  buffer_load_dwordx4 v[188:191], v1, s[12:15], s28 offen offset:3072 sc1
  s_waitcnt vmcnt(16)
  v_pk_add_f32 v[96:97], v[96:97], v[104:105]
  v_pk_add_f32 v[98:99], v[98:99], v[106:107]
  v_pk_add_f32 v[100:101], v[100:101], v[108:109]
  v_pk_add_f32 v[102:103], v[102:103], v[110:111]
  v_pk_add_f32 v[96:97], v[96:97], v[100:101]
  v_pk_add_f32 v[98:99], v[98:99], v[102:103]
  v_pk_add_f32 v[96:97], v[96:97], v[98:99]
  v_add_f32 v96, v96, v97
  v_mov_b32 v97, v96
  s_nop 1
  v_permlane32_swap_b32 v96, v97
  s_nop 1
  v_mul_f32 v96, 0xbb000000, v96
  v_mul_f32 v97, 0x3b000000, v97
  v_fma_f32 v97, -v96, v96, v97
  v_max_f32 v97, 0, v97
  v_add_f32 v113, 0x3727c5ac, v97
  v_rsq_f32 v112, v113
  v_cvt_pk_bf16_f32 v98, v96, v96
  v_and_b32 v98, 0xffff0000, v98
  v_sub_f32 v99, v96, v98
  v_cvt_pk_bf16_f32 v116, v98, v99
  v_mov_b32 v117, v116
  v_mov_b32 v118, v116
  v_mov_b32 v119, v116
  v_and_b32 v3, 31, v0
  v_lshlrev_b32 v3, 2, v3
  s_lshl_b32 s29, s18, 7
  s_add_u32 s29, s29, 155648
  v_add_u32 v3, s29, v3
  ds_write_b32 v3, v112
  v_mfma_f32_32x32x16_bf16 v[32:47], v[84:87], v[116:119], 0
  v_mfma_f32_32x32x16_bf16 v[48:63], v[116:119], v[88:91], 0
  v_mfma_f32_32x32x16_bf16 v[16:31], v[80:83], v[116:119], 0
  v_lshrrev_b32 v3, 5, v0
  v_lshlrev_b32 v3, 4, v3
  v_add_u32 v3, s29, v3
  ds_read_b128 v[96:99], v3 offset:0
  ds_read_b128 v[100:103], v3 offset:32
  ds_read_b128 v[104:107], v3 offset:64
  ds_read_b128 v[108:111], v3 offset:96
  ds_read_b128 v[64:67], v1 offset:0
  ds_read_b128 v[68:71], v1 offset:4096
  s_add_u32 s28, s90, 16384
  buffer_load_dwordx4 v[192:195], v1, s[12:15], s28 offen offset:0 sc1
  ds_read_b128 v[72:75], v1 offset:1024
  ds_read_b128 v[76:79], v1 offset:5120
  s_waitcnt vmcnt(16) lgkmcnt(2)
  v_mfma_f32_32x32x16_bf16 v[32:47], v[64:67], v[128:131], v[32:47]
  v_mfma_f32_32x32x16_bf16 v[48:63], v[128:131], v[68:71], v[48:63]
  buffer_load_dwordx4 v[196:199], v1, s[12:15], s28 offen offset:1024 sc1
  ds_read_b128 v[64:67], v1 offset:2048
  ds_read_b128 v[68:71], v1 offset:6144
  s_waitcnt vmcnt(16) lgkmcnt(2)
  v_mfma_f32_32x32x16_bf16 v[32:47], v[72:75], v[132:135], v[32:47]
  v_mfma_f32_32x32x16_bf16 v[48:63], v[132:135], v[76:79], v[48:63]
  buffer_load_dwordx4 v[200:203], v1, s[12:15], s28 offen offset:2048 sc1
  ds_read_b128 v[72:75], v1 offset:3072
  ds_read_b128 v[76:79], v1 offset:7168
  s_waitcnt vmcnt(16) lgkmcnt(2)
  v_mfma_f32_32x32x16_bf16 v[32:47], v[64:67], v[136:139], v[32:47]
  v_mfma_f32_32x32x16_bf16 v[48:63], v[136:139], v[68:71], v[48:63]
  buffer_load_dwordx4 v[204:207], v1, s[12:15], s28 offen offset:3072 sc1
  ds_read_b128 v[64:67], v1 offset:8192
  ds_read_b128 v[68:71], v1 offset:12288
  s_waitcnt vmcnt(16) lgkmcnt(2)
  v_mfma_f32_32x32x16_bf16 v[32:47], v[72:75], v[140:143], v[32:47]
  v_mfma_f32_32x32x16_bf16 v[48:63], v[140:143], v[76:79], v[48:63]
  s_add_u32 s28, s90, 20480
  buffer_load_dwordx4 v[208:211], v1, s[12:15], s28 offen offset:0 sc1
  ds_read_b128 v[72:75], v1 offset:9216
  ds_read_b128 v[76:79], v1 offset:13312
  s_waitcnt vmcnt(16) lgkmcnt(2)
  v_mfma_f32_32x32x16_bf16 v[32:47], v[64:67], v[144:147], v[32:47]
  v_mfma_f32_32x32x16_bf16 v[48:63], v[144:147], v[68:71], v[48:63]
  buffer_load_dwordx4 v[212:215], v1, s[12:15], s28 offen offset:1024 sc1
  ds_read_b128 v[64:67], v1 offset:10240
  ds_read_b128 v[68:71], v1 offset:14336
  s_waitcnt vmcnt(16) lgkmcnt(2)
  v_mfma_f32_32x32x16_bf16 v[32:47], v[72:75], v[148:151], v[32:47]
  v_mfma_f32_32x32x16_bf16 v[48:63], v[148:151], v[76:79], v[48:63]
  buffer_load_dwordx4 v[216:219], v1, s[12:15], s28 offen offset:2048 sc1
  ds_read_b128 v[72:75], v1 offset:11264
  ds_read_b128 v[76:79], v1 offset:15360
  s_waitcnt vmcnt(16) lgkmcnt(2)
  v_mfma_f32_32x32x16_bf16 v[32:47], v[64:67], v[152:155], v[32:47]
  v_mfma_f32_32x32x16_bf16 v[48:63], v[152:155], v[68:71], v[48:63]
  buffer_load_dwordx4 v[220:223], v1, s[12:15], s28 offen offset:3072 sc1
  ds_read_b128 v[64:67], v1 offset:16384
  ds_read_b128 v[68:71], v1 offset:20480
  s_waitcnt vmcnt(16) lgkmcnt(2)
  v_mfma_f32_32x32x16_bf16 v[32:47], v[72:75], v[156:159], v[32:47]
  v_mfma_f32_32x32x16_bf16 v[48:63], v[156:159], v[76:79], v[48:63]
  s_add_u32 s28, s90, 24576
  buffer_load_dwordx4 v[224:227], v1, s[12:15], s28 offen offset:0 sc1
  ds_read_b128 v[72:75], v1 offset:17408
  ds_read_b128 v[76:79], v1 offset:21504
  s_waitcnt vmcnt(16) lgkmcnt(2)
  v_mfma_f32_32x32x16_bf16 v[32:47], v[64:67], v[160:163], v[32:47]
  v_mfma_f32_32x32x16_bf16 v[48:63], v[160:163], v[68:71], v[48:63]
  buffer_load_dwordx4 v[228:231], v1, s[12:15], s28 offen offset:1024 sc1
  ds_read_b128 v[64:67], v1 offset:18432
  ds_read_b128 v[68:71], v1 offset:22528
  s_waitcnt vmcnt(16) lgkmcnt(2)
  v_mfma_f32_32x32x16_bf16 v[32:47], v[72:75], v[164:167], v[32:47]
  v_mfma_f32_32x32x16_bf16 v[48:63], v[164:167], v[76:79], v[48:63]
  buffer_load_dwordx4 v[232:235], v1, s[12:15], s28 offen offset:2048 sc1
  ds_read_b128 v[72:75], v1 offset:19456
  ds_read_b128 v[76:79], v1 offset:23552
  s_waitcnt vmcnt(16) lgkmcnt(2)
  v_mfma_f32_32x32x16_bf16 v[32:47], v[64:67], v[168:171], v[32:47]
  v_mfma_f32_32x32x16_bf16 v[48:63], v[168:171], v[68:71], v[48:63]
  buffer_load_dwordx4 v[236:239], v1, s[12:15], s28 offen offset:3072 sc1
  ds_read_b128 v[64:67], v1 offset:24576
  ds_read_b128 v[68:71], v1 offset:28672
  s_waitcnt vmcnt(16) lgkmcnt(2)
  v_mfma_f32_32x32x16_bf16 v[32:47], v[72:75], v[172:175], v[32:47]
  v_mfma_f32_32x32x16_bf16 v[48:63], v[172:175], v[76:79], v[48:63]
  s_add_u32 s28, s90, 28672
  buffer_load_dwordx4 v[240:243], v1, s[12:15], s28 offen offset:0 sc1
  ds_read_b128 v[72:75], v1 offset:25600
  ds_read_b128 v[76:79], v1 offset:29696
  s_waitcnt vmcnt(16) lgkmcnt(2)
  v_mfma_f32_32x32x16_bf16 v[32:47], v[64:67], v[176:179], v[32:47]
  v_mfma_f32_32x32x16_bf16 v[48:63], v[176:179], v[68:71], v[48:63]
  buffer_load_dwordx4 v[244:247], v1, s[12:15], s28 offen offset:1024 sc1
  ds_read_b128 v[64:67], v1 offset:26624
  ds_read_b128 v[68:71], v1 offset:30720
  s_waitcnt vmcnt(16) lgkmcnt(2)
  v_mfma_f32_32x32x16_bf16 v[32:47], v[72:75], v[180:183], v[32:47]
  v_mfma_f32_32x32x16_bf16 v[48:63], v[180:183], v[76:79], v[48:63]
  buffer_load_dwordx4 v[248:251], v1, s[12:15], s28 offen offset:2048 sc1
  ds_read_b128 v[72:75], v1 offset:27648
  ds_read_b128 v[76:79], v1 offset:31744
  s_waitcnt vmcnt(16) lgkmcnt(2)
  v_mfma_f32_32x32x16_bf16 v[32:47], v[64:67], v[184:187], v[32:47]
  v_mfma_f32_32x32x16_bf16 v[48:63], v[184:187], v[68:71], v[48:63]
  buffer_load_dwordx4 v[252:255], v1, s[12:15], s28 offen offset:3072 sc1
  ds_read_b128 v[64:67], v1 offset:32768
  ds_read_b128 v[68:71], v1 offset:36864
  s_waitcnt vmcnt(16) lgkmcnt(2)
  v_mfma_f32_32x32x16_bf16 v[32:47], v[72:75], v[188:191], v[32:47]
  v_mfma_f32_32x32x16_bf16 v[48:63], v[188:191], v[76:79], v[48:63]
  ds_read_b128 v[72:75], v1 offset:33792
  ds_read_b128 v[76:79], v1 offset:37888
  s_waitcnt vmcnt(15) lgkmcnt(2)
  v_mfma_f32_32x32x16_bf16 v[32:47], v[64:67], v[192:195], v[32:47]
  v_mfma_f32_32x32x16_bf16 v[48:63], v[192:195], v[68:71], v[48:63]
  ds_read_b128 v[64:67], v1 offset:34816
  ds_read_b128 v[68:71], v1 offset:38912
  s_waitcnt vmcnt(14) lgkmcnt(2)
  v_mfma_f32_32x32x16_bf16 v[32:47], v[72:75], v[196:199], v[32:47]
  v_mfma_f32_32x32x16_bf16 v[48:63], v[196:199], v[76:79], v[48:63]
  ds_read_b128 v[72:75], v1 offset:35840
  ds_read_b128 v[76:79], v1 offset:39936
  s_waitcnt vmcnt(13) lgkmcnt(2)
  v_mfma_f32_32x32x16_bf16 v[32:47], v[64:67], v[200:203], v[32:47]
  v_mfma_f32_32x32x16_bf16 v[48:63], v[200:203], v[68:71], v[48:63]
  ds_read_b128 v[64:67], v1 offset:40960
  ds_read_b128 v[68:71], v1 offset:45056
  s_waitcnt vmcnt(12) lgkmcnt(2)
  v_mfma_f32_32x32x16_bf16 v[32:47], v[72:75], v[204:207], v[32:47]
  v_mfma_f32_32x32x16_bf16 v[48:63], v[204:207], v[76:79], v[48:63]
  ds_read_b128 v[72:75], v1 offset:41984
  ds_read_b128 v[76:79], v1 offset:46080
  s_waitcnt vmcnt(11) lgkmcnt(2)
  v_mfma_f32_32x32x16_bf16 v[32:47], v[64:67], v[208:211], v[32:47]
  v_mfma_f32_32x32x16_bf16 v[48:63], v[208:211], v[68:71], v[48:63]
  ds_read_b128 v[64:67], v1 offset:43008
  ds_read_b128 v[68:71], v1 offset:47104
  s_waitcnt vmcnt(10) lgkmcnt(2)
  v_mfma_f32_32x32x16_bf16 v[32:47], v[72:75], v[212:215], v[32:47]
  v_mfma_f32_32x32x16_bf16 v[48:63], v[212:215], v[76:79], v[48:63]
  ds_read_b128 v[72:75], v1 offset:44032
  ds_read_b128 v[76:79], v1 offset:48128
  s_waitcnt vmcnt(9) lgkmcnt(2)
  v_mfma_f32_32x32x16_bf16 v[32:47], v[64:67], v[216:219], v[32:47]
  v_mfma_f32_32x32x16_bf16 v[48:63], v[216:219], v[68:71], v[48:63]
  ds_read_b128 v[64:67], v1 offset:49152
  ds_read_b128 v[68:71], v1 offset:53248
  s_waitcnt vmcnt(8) lgkmcnt(2)
  v_mfma_f32_32x32x16_bf16 v[32:47], v[72:75], v[220:223], v[32:47]
  v_mfma_f32_32x32x16_bf16 v[48:63], v[220:223], v[76:79], v[48:63]
  ds_read_b128 v[72:75], v1 offset:50176
  ds_read_b128 v[76:79], v1 offset:54272
  s_waitcnt vmcnt(7) lgkmcnt(2)
  v_mfma_f32_32x32x16_bf16 v[32:47], v[64:67], v[224:227], v[32:47]
  v_mfma_f32_32x32x16_bf16 v[48:63], v[224:227], v[68:71], v[48:63]
  ds_read_b128 v[64:67], v1 offset:51200
  ds_read_b128 v[68:71], v1 offset:55296
  s_waitcnt vmcnt(6) lgkmcnt(2)
  v_mfma_f32_32x32x16_bf16 v[32:47], v[72:75], v[228:231], v[32:47]
  v_mfma_f32_32x32x16_bf16 v[48:63], v[228:231], v[76:79], v[48:63]
  ds_read_b128 v[72:75], v1 offset:52224
  ds_read_b128 v[76:79], v1 offset:56320
  s_waitcnt vmcnt(5) lgkmcnt(2)
  v_mfma_f32_32x32x16_bf16 v[32:47], v[64:67], v[232:235], v[32:47]
  v_mfma_f32_32x32x16_bf16 v[48:63], v[232:235], v[68:71], v[48:63]
  ds_read_b128 v[64:67], v1 offset:57344
  ds_read_b128 v[68:71], v4 offset:0
  s_waitcnt vmcnt(4) lgkmcnt(2)
  v_mfma_f32_32x32x16_bf16 v[32:47], v[72:75], v[236:239], v[32:47]
  v_mfma_f32_32x32x16_bf16 v[48:63], v[236:239], v[76:79], v[48:63]
  ds_read_b128 v[72:75], v1 offset:58368
  ds_read_b128 v[76:79], v4 offset:1024
  s_waitcnt vmcnt(3) lgkmcnt(2)
  v_mfma_f32_32x32x16_bf16 v[32:47], v[64:67], v[240:243], v[32:47]
  v_mfma_f32_32x32x16_bf16 v[48:63], v[240:243], v[68:71], v[48:63]
  ds_read_b128 v[64:67], v1 offset:59392
  ds_read_b128 v[68:71], v4 offset:2048
  s_waitcnt vmcnt(2) lgkmcnt(2)
  v_mfma_f32_32x32x16_bf16 v[32:47], v[72:75], v[244:247], v[32:47]
  v_mfma_f32_32x32x16_bf16 v[48:63], v[244:247], v[76:79], v[48:63]
  ds_read_b128 v[72:75], v1 offset:60416
  ds_read_b128 v[76:79], v4 offset:3072
  s_waitcnt vmcnt(1) lgkmcnt(2)
  v_mfma_f32_32x32x16_bf16 v[32:47], v[64:67], v[248:251], v[32:47]
  v_mfma_f32_32x32x16_bf16 v[48:63], v[248:251], v[68:71], v[48:63]
  s_waitcnt vmcnt(0) lgkmcnt(0)
  v_mfma_f32_32x32x16_bf16 v[32:47], v[72:75], v[252:255], v[32:47]
  v_mfma_f32_32x32x16_bf16 v[48:63], v[252:255], v[76:79], v[48:63]
  s_lshl_b32 s28, s19, 4
  s_add_u32 s28, s28, s17
  s_lshl_b32 s28, s28, 12
  s_add_u32 s28, s28, 0x600000
  s_lshl_b32 s31, s20, 25
  s_add_u32 s28, s28, s31
  s_nop 5
  v_pk_mul_f32 v[32:33], v[32:33], v[112:113] op_sel:[0,0] op_sel_hi:[1,0]
  v_pk_mul_f32 v[34:35], v[34:35], v[112:113] op_sel:[0,0] op_sel_hi:[1,0]
  v_pk_mul_f32 v[36:37], v[36:37], v[112:113] op_sel:[0,0] op_sel_hi:[1,0]
  v_pk_mul_f32 v[38:39], v[38:39], v[112:113] op_sel:[0,0] op_sel_hi:[1,0]
  v_cvt_pk_bf16_f32 v120, v32, v33
  v_cvt_pk_bf16_f32 v121, v34, v35
  v_cvt_pk_bf16_f32 v122, v36, v37
  v_cvt_pk_bf16_f32 v123, v38, v39
  buffer_store_dwordx4 v[120:123], v1, s[12:15], s28 offen offset:0 sc1
  v_pk_mul_f32 v[40:41], v[40:41], v[112:113] op_sel:[0,0] op_sel_hi:[1,0]
  v_pk_mul_f32 v[42:43], v[42:43], v[112:113] op_sel:[0,0] op_sel_hi:[1,0]
  v_pk_mul_f32 v[44:45], v[44:45], v[112:113] op_sel:[0,0] op_sel_hi:[1,0]
  v_pk_mul_f32 v[46:47], v[46:47], v[112:113] op_sel:[0,0] op_sel_hi:[1,0]
  v_cvt_pk_bf16_f32 v124, v40, v41
  v_cvt_pk_bf16_f32 v125, v42, v43
  v_cvt_pk_bf16_f32 v126, v44, v45
  v_cvt_pk_bf16_f32 v127, v46, v47
  buffer_store_dwordx4 v[124:127], v1, s[12:15], s28 offen offset:1024 sc1
  v_pk_mul_f32 v[48:49], v[48:49], v[96:97] op_sel:[0,0] op_sel_hi:[1,1]
  v_pk_mul_f32 v[50:51], v[50:51], v[98:99] op_sel:[0,0] op_sel_hi:[1,1]
  v_pk_mul_f32 v[52:53], v[52:53], v[100:101] op_sel:[0,0] op_sel_hi:[1,1]
  v_pk_mul_f32 v[54:55], v[54:55], v[102:103] op_sel:[0,0] op_sel_hi:[1,1]
  v_cvt_pk_bf16_f32 v84, v48, v49
  v_cvt_pk_bf16_f32 v85, v50, v51
  v_cvt_pk_bf16_f32 v86, v52, v53
  v_cvt_pk_bf16_f32 v87, v54, v55
  buffer_store_dwordx4 v[84:87], v1, s[12:15], s28 offen offset:2048 sc1
  v_pk_mul_f32 v[56:57], v[56:57], v[104:105] op_sel:[0,0] op_sel_hi:[1,1]
  v_pk_mul_f32 v[58:59], v[58:59], v[106:107] op_sel:[0,0] op_sel_hi:[1,1]
  v_pk_mul_f32 v[60:61], v[60:61], v[108:109] op_sel:[0,0] op_sel_hi:[1,1]
  v_pk_mul_f32 v[62:63], v[62:63], v[110:111] op_sel:[0,0] op_sel_hi:[1,1]
  v_cvt_pk_bf16_f32 v88, v56, v57
  v_cvt_pk_bf16_f32 v89, v58, v59
  v_cvt_pk_bf16_f32 v90, v60, v61
  v_cvt_pk_bf16_f32 v91, v62, v63
  buffer_store_dwordx4 v[88:91], v1, s[12:15], s28 offen offset:3072 sc1
  s_barrier
  ds_read_b128 v[64:67], v4 offset:4096
  ds_read_b128 v[68:71], v4 offset:5120
  ds_read_b128 v[72:75], v4 offset:6144
  ds_read_b128 v[76:79], v4 offset:7168
  s_waitcnt lgkmcnt(3)
  v_mfma_f32_32x32x16_bf16 v[16:31], v[64:67], v[128:131], v[16:31]
  ds_read_b128 v[64:67], v4 offset:8192
  s_waitcnt lgkmcnt(3)
  v_mfma_f32_32x32x16_bf16 v[16:31], v[68:71], v[132:135], v[16:31]
  ds_read_b128 v[68:71], v4 offset:9216
  s_waitcnt lgkmcnt(3)
  v_mfma_f32_32x32x16_bf16 v[16:31], v[72:75], v[136:139], v[16:31]
  ds_read_b128 v[72:75], v4 offset:10240
  s_waitcnt lgkmcnt(3)
  v_mfma_f32_32x32x16_bf16 v[16:31], v[76:79], v[140:143], v[16:31]
  ds_read_b128 v[76:79], v4 offset:11264
  s_waitcnt lgkmcnt(3)
  v_mfma_f32_32x32x16_bf16 v[16:31], v[64:67], v[144:147], v[16:31]
  ds_read_b128 v[64:67], v4 offset:12288
  s_waitcnt lgkmcnt(3)
  v_mfma_f32_32x32x16_bf16 v[16:31], v[68:71], v[148:151], v[16:31]
  ds_read_b128 v[68:71], v4 offset:13312
  s_waitcnt lgkmcnt(3)
  v_mfma_f32_32x32x16_bf16 v[16:31], v[72:75], v[152:155], v[16:31]
  ds_read_b128 v[72:75], v4 offset:14336
  s_waitcnt lgkmcnt(3)
  v_mfma_f32_32x32x16_bf16 v[16:31], v[76:79], v[156:159], v[16:31]
  ds_read_b128 v[76:79], v4 offset:15360
  s_waitcnt lgkmcnt(3)
  v_mfma_f32_32x32x16_bf16 v[16:31], v[64:67], v[160:163], v[16:31]
  ds_read_b128 v[64:67], v4 offset:16384
  s_waitcnt lgkmcnt(3)
  v_mfma_f32_32x32x16_bf16 v[16:31], v[68:71], v[164:167], v[16:31]
  ds_read_b128 v[68:71], v4 offset:17408
  s_waitcnt lgkmcnt(3)
  v_mfma_f32_32x32x16_bf16 v[16:31], v[72:75], v[168:171], v[16:31]
  ds_read_b128 v[72:75], v4 offset:18432
  s_waitcnt lgkmcnt(3)
  v_mfma_f32_32x32x16_bf16 v[16:31], v[76:79], v[172:175], v[16:31]
  ds_read_b128 v[76:79], v4 offset:19456
  s_waitcnt lgkmcnt(3)
  v_mfma_f32_32x32x16_bf16 v[16:31], v[64:67], v[176:179], v[16:31]
  s_lshl_b32 s28, s19, 11
  s_lshl_b32 s29, s17, 7
  s_add_u32 s28, s28, s29
  s_add_u32 s28, s28, 0x1040000
  s_lshl_b32 s31, s20, 25
  s_add_u32 s28, s28, s31
  v_mov_b32 v7, s98
  v_mov_b32 v8, 0
  s_waitcnt vmcnt(0)
  s_mov_b64 exec, 1
  buffer_store_dword v7, v8, s[12:15], s28 offen sc1
  s_mov_b64 exec, -1
  ds_read_b128 v[64:67], v4 offset:20480
  s_waitcnt lgkmcnt(3)
  v_mfma_f32_32x32x16_bf16 v[16:31], v[68:71], v[180:183], v[16:31]
  ds_read_b128 v[68:71], v4 offset:21504
  s_waitcnt lgkmcnt(3)
  v_mfma_f32_32x32x16_bf16 v[16:31], v[72:75], v[184:187], v[16:31]
  ds_read_b128 v[72:75], v4 offset:22528
  s_waitcnt lgkmcnt(3)
  v_mfma_f32_32x32x16_bf16 v[16:31], v[76:79], v[188:191], v[16:31]
  ds_read_b128 v[76:79], v4 offset:23552
  s_waitcnt lgkmcnt(3)
  v_mfma_f32_32x32x16_bf16 v[16:31], v[64:67], v[192:195], v[16:31]
  ds_read_b128 v[64:67], v4 offset:24576
  s_waitcnt lgkmcnt(3)
  v_mfma_f32_32x32x16_bf16 v[16:31], v[68:71], v[196:199], v[16:31]
  ds_read_b128 v[68:71], v4 offset:25600
  s_waitcnt lgkmcnt(3)
  v_mfma_f32_32x32x16_bf16 v[16:31], v[72:75], v[200:203], v[16:31]
  ds_read_b128 v[72:75], v4 offset:26624
  s_waitcnt lgkmcnt(3)
  v_mfma_f32_32x32x16_bf16 v[16:31], v[76:79], v[204:207], v[16:31]
  ds_read_b128 v[76:79], v4 offset:27648
  s_waitcnt lgkmcnt(3)
  v_mfma_f32_32x32x16_bf16 v[16:31], v[64:67], v[208:211], v[16:31]
  ds_read_b128 v[64:67], v4 offset:28672
  s_waitcnt lgkmcnt(3)
  v_mfma_f32_32x32x16_bf16 v[16:31], v[68:71], v[212:215], v[16:31]
  ds_read_b128 v[68:71], v4 offset:29696
  s_waitcnt lgkmcnt(3)
  v_mfma_f32_32x32x16_bf16 v[16:31], v[72:75], v[216:219], v[16:31]
  ds_read_b128 v[72:75], v4 offset:30720
  s_waitcnt lgkmcnt(3)
  v_mfma_f32_32x32x16_bf16 v[16:31], v[76:79], v[220:223], v[16:31]
  ds_read_b128 v[76:79], v4 offset:31744
  s_waitcnt lgkmcnt(3)
  v_mfma_f32_32x32x16_bf16 v[16:31], v[64:67], v[224:227], v[16:31]
  ds_read_b128 v[64:67], v4 offset:32768
  s_waitcnt lgkmcnt(3)
  v_mfma_f32_32x32x16_bf16 v[16:31], v[68:71], v[228:231], v[16:31]
  ds_read_b128 v[68:71], v4 offset:33792
  s_waitcnt lgkmcnt(3)
  v_mfma_f32_32x32x16_bf16 v[16:31], v[72:75], v[232:235], v[16:31]
  ds_read_b128 v[72:75], v4 offset:34816
  s_waitcnt lgkmcnt(3)
  v_mfma_f32_32x32x16_bf16 v[16:31], v[76:79], v[236:239], v[16:31]
  ds_read_b128 v[76:79], v4 offset:35840
  s_waitcnt lgkmcnt(3)
  v_mfma_f32_32x32x16_bf16 v[16:31], v[64:67], v[240:243], v[16:31]
  s_waitcnt lgkmcnt(2)
  v_mfma_f32_32x32x16_bf16 v[16:31], v[68:71], v[244:247], v[16:31]
  s_waitcnt lgkmcnt(1)
  v_mfma_f32_32x32x16_bf16 v[16:31], v[72:75], v[248:251], v[16:31]
  s_waitcnt lgkmcnt(0)
  v_mfma_f32_32x32x16_bf16 v[16:31], v[76:79], v[252:255], v[16:31]
  s_add_u32 s29, s22, 131072
  v_add_u32 v3, s29, v1
  ds_write_b128 v3, v[120:123] offset:0
  ds_write_b128 v3, v[124:127] offset:1024
  ds_write_b128 v3, v[84:87] offset:2048
  ds_write_b128 v3, v[88:91] offset:3072
  v_mul_f32 v114, 0x3eb8aa3b, v112
  s_nop 5
  v_pk_mul_f32 v[16:17], v[16:17], v[114:115] op_sel:[0,0] op_sel_hi:[1,0]
  v_pk_mul_f32 v[18:19], v[18:19], v[114:115] op_sel:[0,0] op_sel_hi:[1,0]
  v_pk_mul_f32 v[20:21], v[20:21], v[114:115] op_sel:[0,0] op_sel_hi:[1,0]
  v_pk_mul_f32 v[22:23], v[22:23], v[114:115] op_sel:[0,0] op_sel_hi:[1,0]
  v_pk_mul_f32 v[24:25], v[24:25], v[114:115] op_sel:[0,0] op_sel_hi:[1,0]
  v_pk_mul_f32 v[26:27], v[26:27], v[114:115] op_sel:[0,0] op_sel_hi:[1,0]
  v_pk_mul_f32 v[28:29], v[28:29], v[114:115] op_sel:[0,0] op_sel_hi:[1,0]
  v_pk_mul_f32 v[30:31], v[30:31], v[114:115] op_sel:[0,0] op_sel_hi:[1,0]
  v_cvt_pk_bf16_f32 v96, v16, v17
  v_cvt_pk_bf16_f32 v97, v18, v19
  v_cvt_pk_bf16_f32 v98, v20, v21
  v_cvt_pk_bf16_f32 v99, v22, v23
  v_cvt_pk_bf16_f32 v100, v24, v25
  v_cvt_pk_bf16_f32 v101, v26, v27
  v_cvt_pk_bf16_f32 v102, v28, v29
  v_cvt_pk_bf16_f32 v103, v30, v31
  s_lshl_b32 s29, s18, 11
  s_add_u32 s29, s29, 147456
  v_add_u32 v3, s29, v1
  ds_write_b128 v3, v[96:99] offset:0
  ds_write_b128 v3, v[100:103] offset:1024
  v_mov_b32 v8, 0xffff
  v_mov_b32 v9, 0xffff0000
  v_cndmask_b32 v232, 0, v8, s[32:33]
  v_cndmask_b32 v7, 0, v9, s[34:35]
  v_or_b32 v232, v232, v7
  v_cndmask_b32 v233, 0, v8, s[36:37]
  v_cndmask_b32 v7, 0, v9, s[38:39]
  v_or_b32 v233, v233, v7
  v_cndmask_b32 v234, 0, v8, s[40:41]
  v_cndmask_b32 v7, 0, v9, s[42:43]
  v_or_b32 v234, v234, v7
  v_cndmask_b32 v235, 0, v8, s[44:45]
  v_cndmask_b32 v7, 0, v9, s[46:47]
  v_or_b32 v235, v235, v7
  v_cndmask_b32 v236, 0, v8, s[48:49]
  v_cndmask_b32 v7, 0, v9, s[50:51]
  v_or_b32 v236, v236, v7
  v_cndmask_b32 v237, 0, v8, s[52:53]
  v_cndmask_b32 v7, 0, v9, s[54:55]
  v_or_b32 v237, v237, v7
  v_cndmask_b32 v238, 0, v8, s[56:57]
  v_cndmask_b32 v7, 0, v9, s[58:59]
  v_or_b32 v238, v238, v7
  v_cndmask_b32 v239, 0, v8, s[60:61]
  v_cndmask_b32 v7, 0, v9, s[62:63]
  v_or_b32 v239, v239, v7
  v_mov_b32 v216, 0x3f803f80
  v_mov_b32 v217, 0x3f803f80
  v_mov_b32 v218, 0x3f803f80
  v_mov_b32 v219, 0x3f803f80
  v_mov_b32 v220, 0x3f803f80
  v_mov_b32 v221, 0x3f803f80
  v_mov_b32 v222, 0x3f803f80
  v_mov_b32 v223, 0x3f803f80
  v_mov_b32 v224, 0x3f803f80
  v_mov_b32 v225, 0x3f803f80
  v_mov_b32 v226, 0x3f803f80
  v_mov_b32 v227, 0x3f803f80
  v_mov_b32 v228, 0x3f803f80
  v_mov_b32 v229, 0x3f803f80
  v_mov_b32 v230, 0x3f803f80
  v_mov_b32 v231, 0x3f803f80
  s_setprio 0
  s_cmp_lg_u32 s20, 0
  s_cbranch_scc1 L_att
  s_and_b32 s28, s2, 15
  s_lshl_b32 s28, s28, 11
  s_add_u32 s28, s28, 0x4730000
  s_mul_i32 s29, s18, 9472
  s_add_u32 s29, s29, 0x4703000
  s_getreg_b32 s30, hwreg(HW_REG_XCC_ID, 0, 4)
  s_add_u32 s30, s30, s98
  v_lshlrev_b32 v3, 7, v0
  v_and_b32 v10, 0x780, v3
  s_mov_b32 s31, 0
L_cspin:
  buffer_load_dword v6, v3, s[8:11], s29 offen sc1
  buffer_load_dword v7, v3, s[8:11], s29 offen offset:1280 sc1
  buffer_load_dword v9, v10, s[8:11], s28 offen sc1
  s_waitcnt vmcnt(0)
  v_subrev_u32 v8, s98, v9
  v_lshrrev_b32 v8, 4, v8
  v_xor_b32 v6, s98, v6
  v_xor_b32 v7, s98, v7
  v_or3_b32 v6, v6, v7, v8
  v_cmp_eq_u32 vcc, 0, v6
  s_nop 1
  s_cmp_eq_u64 vcc, -1
  s_cbranch_scc1 L_cok
  s_add_u32 s31, s31, 1
  s_cmp_lt_u32 s31, 0x20000
  s_cbranch_scc1 L_cspin
L_cok:
  v_cmp_eq_u32 vcc, s30, v9
  s_nop 1
  s_cmp_eq_u64 vcc, -1
  s_cselect_b32 s101, 1, 0
  v_mov_b32 v6, s101
  v_mov_b32 v7, 156672
  ds_write_b32 v7, v6
  s_branch L_att
L_Linit:
  s_setprio 1
  buffer_load_dwordx4 v[248:251], v1, s[12:15], s95 offen sc1
  buffer_load_dwordx4 v[252:255], v1, s[12:15], s95 offen offset:1024 sc1
  s_branch L_Ltop0
L_Ltop:
  s_setprio 0
  s_barrier
L_Ltop0:
  s_add_u32 s91, s100, s22
  s_add_u32 m0, s22, 65536
  s_add_u32 s30, s91, 0
  s_and_b32 s30, s30, 0x7fff
  s_add_u32 s30, s30, s24
  buffer_load_dwordx4 v1, s[8:11], s30 offen offset:0  lds
  buffer_load_dwordx4 v1, s[8:11], s30 offen offset:1024  lds
  buffer_load_dwordx4 v1, s[8:11], s30 offen offset:2048  lds
  buffer_load_dwordx4 v1, s[8:11], s30 offen offset:3072  lds
  s_add_u32 m0, s22, 81920
  s_add_u32 s30, s91, 16384
  s_and_b32 s30, s30, 0x7fff
  s_add_u32 s30, s30, s24
  buffer_load_dwordx4 v1, s[8:11], s30 offen offset:0  lds
  buffer_load_dwordx4 v1, s[8:11], s30 offen offset:1024  lds
  buffer_load_dwordx4 v1, s[8:11], s30 offen offset:2048  lds
  buffer_load_dwordx4 v1, s[8:11], s30 offen offset:3072  lds
L_Lnoq:
  v_mov_b32 v8, 0xffff
  v_mov_b32 v9, 0xffff0000
  v_cndmask_b32 v232, 0, v8, s[32:33]
  v_cndmask_b32 v7, 0, v9, s[34:35]
  v_or_b32 v232, v232, v7
  v_cndmask_b32 v233, 0, v8, s[36:37]
  v_cndmask_b32 v7, 0, v9, s[38:39]
  v_or_b32 v233, v233, v7
  v_cndmask_b32 v234, 0, v8, s[40:41]
  v_cndmask_b32 v7, 0, v9, s[42:43]
  v_or_b32 v234, v234, v7
  v_cndmask_b32 v235, 0, v8, s[44:45]
  v_cndmask_b32 v7, 0, v9, s[46:47]
  v_or_b32 v235, v235, v7
  v_cndmask_b32 v236, 0, v8, s[48:49]
  v_cndmask_b32 v7, 0, v9, s[50:51]
  v_or_b32 v236, v236, v7
  v_cndmask_b32 v237, 0, v8, s[52:53]
  v_cndmask_b32 v7, 0, v9, s[54:55]
  v_or_b32 v237, v237, v7
  v_cndmask_b32 v238, 0, v8, s[56:57]
  v_cndmask_b32 v7, 0, v9, s[58:59]
  v_or_b32 v238, v238, v7
  v_cndmask_b32 v239, 0, v8, s[60:61]
  v_cndmask_b32 v7, 0, v9, s[62:63]
  v_or_b32 v239, v239, v7
  v_mov_b32 v216, 0x3f803f80
  v_mov_b32 v217, 0x3f803f80
  v_mov_b32 v218, 0x3f803f80
  v_mov_b32 v219, 0x3f803f80
  v_mov_b32 v220, 0x3f803f80
  v_mov_b32 v221, 0x3f803f80
  v_mov_b32 v222, 0x3f803f80
  v_mov_b32 v223, 0x3f803f80
  v_mov_b32 v224, 0x3f803f80
  v_mov_b32 v225, 0x3f803f80
  v_mov_b32 v226, 0x3f803f80
  v_mov_b32 v227, 0x3f803f80
  v_mov_b32 v228, 0x3f803f80
  v_mov_b32 v229, 0x3f803f80
  v_mov_b32 v230, 0x3f803f80
  v_mov_b32 v231, 0x3f803f80
  s_waitcnt vmcnt(0)
  s_barrier
L_Lpostq:
  s_mov_b32 s28, 0x40000000
  s_mov_b32 s29, 0x40000000
  s_cmp_eq_u32 s16, 0
  s_cbranch_scc1 L_Lnokv
  s_sub_u32 s28, s19, 4
  s_lshl_b32 s30, s28, 11
  s_lshl_b32 s31, s17, 7
  s_add_u32 s30, s30, s31
  s_add_u32 s30, s30, 0x103e000
  s_lshl_b32 s31, s20, 25
  s_add_u32 s30, s30, s31
  s_cmp_eq_u32 s16, 1
  s_cselect_b32 s31, 0, 8192
  v_lshrrev_b32 v3, 5, v0
  v_mul_lo_u32 v3, v3, s31
  v_sub_u32 v3, 8192, v3
  s_lshl_b32 s28, s28, 4
  s_add_u32 s28, s28, s17
  s_lshl_b32 s28, s28, 12
  s_add_u32 s28, s28, 0x600000
  s_lshl_b32 s31, s20, 25
  s_add_u32 s28, s28, s31
  s_sub_u32 s29, s28, 262144
  s_cmp_eq_u32 s16, 1
  s_cselect_b32 s29, 0x40000000, s29
  s_mov_b32 s31, 0
L_interleave_layers__sliding_block__glu_gated_swiglu__prompt_5:
  buffer_load_dword v6, v3, s[12:15], s30 offen sc1
  s_waitcnt vmcnt(0)
  v_cmp_eq_u32 vcc, s98, v6
  s_nop 1
  s_cmp_eq_u64 vcc, -1
  s_cbranch_scc1 L_interleave_layers__sliding_block__glu_gated_swiglu__prompt_6
  s_add_u32 s31, s31, 1
  s_cmp_lt_u32 s31, 0x20000
  s_cbranch_scc1 L_interleave_layers__sliding_block__glu_gated_swiglu__prompt_5
L_interleave_layers__sliding_block__glu_gated_swiglu__prompt_6:
L_Lnokv:
  buffer_load_dwordx4 v[16:19], v1, s[12:15], s28 offen offset:0 sc1
  buffer_load_dwordx4 v[20:23], v1, s[12:15], s28 offen offset:1024 sc1
  buffer_load_dwordx4 v[24:27], v1, s[12:15], s28 offen offset:2048 sc1
  buffer_load_dwordx4 v[28:31], v1, s[12:15], s28 offen offset:3072 sc1
  buffer_load_dwordx4 v[32:35], v1, s[12:15], s29 offen offset:0 sc1
  buffer_load_dwordx4 v[36:39], v1, s[12:15], s29 offen offset:1024 sc1
  buffer_load_dwordx4 v[40:43], v1, s[12:15], s29 offen offset:2048 sc1
  buffer_load_dwordx4 v[44:47], v1, s[12:15], s29 offen offset:3072 sc1
  s_add_u32 s29, s22, 98304
  v_add_u32 v3, s29, v1
  s_waitcnt vmcnt(4)
  ds_write_b128 v3, v[16:19] offset:16384
  ds_write_b128 v3, v[20:23] offset:17408
  ds_write_b128 v3, v[24:27] offset:18432
  ds_write_b128 v3, v[28:31] offset:19456
  s_waitcnt vmcnt(0)
  ds_write_b128 v3, v[32:35] offset:0
  ds_write_b128 v3, v[36:39] offset:1024
  ds_write_b128 v3, v[40:43] offset:2048
  ds_write_b128 v3, v[44:47] offset:3072
  s_setprio 0
L_att:
  s_lshr_b32 s86, s3, 2
  s_add_u32 s29, s22, 98304
  v_add_u32 v10, s29, v1
  s_lshl_b32 s28, s86, 10
  v_add_u32 v3, s28, v10
  s_lshl_b32 s29, s18, 11
  s_add_u32 s29, s29, s28
  s_add_u32 s29, s29, 147456
  v_add_u32 v11, s29, v1
  s_lshl_b32 s28, s86, 4
  s_lshl_b32 s88, 0xffff, s28
  s_mov_b32 s89, s88
  s_sub_i32 s87, 8, s19
  s_max_i32 s87, s87, 0
  s_lshl_b32 s28, s19, 15
  s_lshl_b32 s29, s17, 11
  s_add_u32 s28, s28, s29
  s_add_u32 s28, s28, 0x400000
  v_lshlrev_b32 v246, 7, v0
  v_add_u32 v246, s28, v246
  s_mul_i32 s28, s19, 90112
  s_lshl_b32 s29, s17, 11
  s_add_u32 s28, s28, s29
  s_add_u32 s28, s28, 0xa00000
  v_subrev_u32 v7, 16, v0
  v_lshlrev_b32 v7, 7, v7
  v_add_u32 v7, s28, v7
  v_cmp_le_u32 vcc, 16, v0
  s_nop 1
  v_cndmask_b32 v246, v246, v7, vcc
  s_add_u32 s28, s28, 32768
  v_subrev_u32 v7, 32, v0
  v_lshlrev_b32 v7, 7, v7
  v_add_u32 v7, s28, v7
  v_cmp_le_u32 vcc, 32, v0
  s_nop 1
  v_cndmask_b32 v246, v246, v7, vcc
  s_add_u32 s28, s28, 28672
  v_subrev_u32 v7, 48, v0
  v_lshlrev_b32 v7, 7, v7
  v_add_u32 v7, s28, v7
  v_cmp_le_u32 vcc, 48, v0
  s_nop 1
  v_cndmask_b32 v246, v246, v7, vcc
  s_waitcnt lgkmcnt(0)
  s_barrier
  v_mov_b32 v7, 156672
  ds_read_b32 v12, v7
  ds_read_b128 v[196:199], v11
  ds_read_b128 v[160:163], v3 offset:0
  ds_read_b128 v[164:167], v3 offset:4096
  ds_read_b128 v[168:171], v3 offset:8192
  ds_read_b128 v[172:175], v3 offset:12288
  ds_read_b128 v[176:179], v3 offset:16384
  ds_read_b128 v[180:183], v3 offset:20480
  ds_read_b128 v[184:187], v3 offset:24576
  ds_read_b128 v[188:191], v3 offset:28672
  ds_read_b128 v[192:195], v3 offset:32768
  s_lshl_b32 s28, s86, 14
  s_add_u32 s90, s25, s28
  s_lshl_b32 s28, s86, 15
  s_add_u32 s22, s22, s28
  s_waitcnt lgkmcnt(8)
  v_mfma_f32_32x32x16_bf16 v[16:31], v[160:163], v[196:199], 0
  s_waitcnt lgkmcnt(7)
  v_mfma_f32_32x32x16_bf16 v[32:47], v[164:167], v[196:199], 0
  s_waitcnt lgkmcnt(6)
  v_mfma_f32_32x32x16_bf16 v[48:63], v[168:171], v[196:199], 0
  s_waitcnt lgkmcnt(5)
  v_mfma_f32_32x32x16_bf16 v[64:79], v[172:175], v[196:199], 0
  s_waitcnt lgkmcnt(4)
  v_mfma_f32_32x32x16_bf16 v[80:95], v[176:179], v[196:199], 0
  s_waitcnt lgkmcnt(3)
  v_mfma_f32_32x32x16_bf16 v[96:111], v[180:183], v[196:199], 0
  s_waitcnt lgkmcnt(2)
  v_mfma_f32_32x32x16_bf16 v[112:127], v[184:187], v[196:199], 0
  s_waitcnt lgkmcnt(1)
  v_mfma_f32_32x32x16_bf16 v[128:143], v[188:191], v[196:199], 0
  s_waitcnt lgkmcnt(0)
  v_mfma_f32_32x32x16_bf16 v[144:159], v[192:195], v[196:199], 0
  v_readfirstlane_b32 s29, v12
  s_cmp_eq_u32 s20, 0
  s_cselect_b32 s101, s29, s101
  s_sub_u32 s22, s22, s28
  s_add_u32 s96, s22, s28
  s_lshr_b32 s28, s28, 1
  s_add_u32 s97, s22, s28
  s_lshr_b32 s91, s28, 1
  s_add_u32 s91, s91, s99
  s_and_b32 s91, s91, 0x7fff
  s_add_u32 s91, s91, s26
  s_cmp_lg_u32 s86, 0
  s_cbranch_scc1 L_interleave_layers__sliding_block__glu_gated_swiglu__prompt_7
  s_add_u32 m0, s22, 0
  s_add_u32 s30, s25, 0
  buffer_load_dwordx4 v1, s[8:11], s30 offen offset:0 lds
  s_add_u32 m0, s22, 0
  s_add_u32 s30, s25, 0
  buffer_load_dwordx4 v1, s[8:11], s30 offen offset:1024 lds
  s_cmp_lg_u32 s20, 0
  s_cbranch_scc1 L_tch5
  buffer_load_dword v245, v246, s[12:15], 0 offen sc1
L_tch5:
L_interleave_layers__sliding_block__glu_gated_swiglu__prompt_7:
  s_nop 3
  s_cmp_le_u32 s87, 0
  s_cbranch_scc1 L_inv
  v_mov_b32 v16, 0xff800000
  v_mov_b32 v17, 0xff800000
  v_mov_b32 v18, 0xff800000
  v_mov_b32 v19, 0xff800000
  v_mov_b32 v20, 0xff800000
  v_mov_b32 v21, 0xff800000
  v_mov_b32 v22, 0xff800000
  v_mov_b32 v23, 0xff800000
  v_mov_b32 v24, 0xff800000
  v_mov_b32 v25, 0xff800000
  v_mov_b32 v26, 0xff800000
  v_mov_b32 v27, 0xff800000
  v_mov_b32 v28, 0xff800000
  v_mov_b32 v29, 0xff800000
  v_mov_b32 v30, 0xff800000
  v_mov_b32 v31, 0xff800000
  s_cmp_le_u32 s87, 1
  s_cbranch_scc1 L_inv
  v_mov_b32 v32, 0xff800000
  v_mov_b32 v33, 0xff800000
  v_mov_b32 v34, 0xff800000
  v_mov_b32 v35, 0xff800000
  v_mov_b32 v36, 0xff800000
  v_mov_b32 v37, 0xff800000
  v_mov_b32 v38, 0xff800000
  v_mov_b32 v39, 0xff800000
  v_mov_b32 v40, 0xff800000
  v_mov_b32 v41, 0xff800000
  v_mov_b32 v42, 0xff800000
  v_mov_b32 v43, 0xff800000
  v_mov_b32 v44, 0xff800000
  v_mov_b32 v45, 0xff800000
  v_mov_b32 v46, 0xff800000
  v_mov_b32 v47, 0xff800000
  s_cmp_le_u32 s87, 2
  s_cbranch_scc1 L_inv
  v_mov_b32 v48, 0xff800000
  v_mov_b32 v49, 0xff800000
  v_mov_b32 v50, 0xff800000
  v_mov_b32 v51, 0xff800000
  v_mov_b32 v52, 0xff800000
  v_mov_b32 v53, 0xff800000
  v_mov_b32 v54, 0xff800000
  v_mov_b32 v55, 0xff800000
  v_mov_b32 v56, 0xff800000
  v_mov_b32 v57, 0xff800000
  v_mov_b32 v58, 0xff800000
  v_mov_b32 v59, 0xff800000
  v_mov_b32 v60, 0xff800000
  v_mov_b32 v61, 0xff800000
  v_mov_b32 v62, 0xff800000
  v_mov_b32 v63, 0xff800000
  s_cmp_le_u32 s87, 3
  s_cbranch_scc1 L_inv
  v_mov_b32 v64, 0xff800000
  v_mov_b32 v65, 0xff800000
  v_mov_b32 v66, 0xff800000
  v_mov_b32 v67, 0xff800000
  v_mov_b32 v68, 0xff800000
  v_mov_b32 v69, 0xff800000
  v_mov_b32 v70, 0xff800000
  v_mov_b32 v71, 0xff800000
  v_mov_b32 v72, 0xff800000
  v_mov_b32 v73, 0xff800000
  v_mov_b32 v74, 0xff800000
  v_mov_b32 v75, 0xff800000
  v_mov_b32 v76, 0xff800000
  v_mov_b32 v77, 0xff800000
  v_mov_b32 v78, 0xff800000
  v_mov_b32 v79, 0xff800000
  s_cmp_le_u32 s87, 4
  s_cbranch_scc1 L_inv
  v_mov_b32 v80, 0xff800000
  v_mov_b32 v81, 0xff800000
  v_mov_b32 v82, 0xff800000
  v_mov_b32 v83, 0xff800000
  v_mov_b32 v84, 0xff800000
  v_mov_b32 v85, 0xff800000
  v_mov_b32 v86, 0xff800000
  v_mov_b32 v87, 0xff800000
  v_mov_b32 v88, 0xff800000
  v_mov_b32 v89, 0xff800000
  v_mov_b32 v90, 0xff800000
  v_mov_b32 v91, 0xff800000
  v_mov_b32 v92, 0xff800000
  v_mov_b32 v93, 0xff800000
  v_mov_b32 v94, 0xff800000
  v_mov_b32 v95, 0xff800000
  s_cmp_le_u32 s87, 5
  s_cbranch_scc1 L_inv
  v_mov_b32 v96, 0xff800000
  v_mov_b32 v97, 0xff800000
  v_mov_b32 v98, 0xff800000
  v_mov_b32 v99, 0xff800000
  v_mov_b32 v100, 0xff800000
  v_mov_b32 v101, 0xff800000
  v_mov_b32 v102, 0xff800000
  v_mov_b32 v103, 0xff800000
  v_mov_b32 v104, 0xff800000
  v_mov_b32 v105, 0xff800000
  v_mov_b32 v106, 0xff800000
  v_mov_b32 v107, 0xff800000
  v_mov_b32 v108, 0xff800000
  v_mov_b32 v109, 0xff800000
  v_mov_b32 v110, 0xff800000
  v_mov_b32 v111, 0xff800000
  s_cmp_le_u32 s87, 6
  s_cbranch_scc1 L_inv
  v_mov_b32 v112, 0xff800000
  v_mov_b32 v113, 0xff800000
  v_mov_b32 v114, 0xff800000
  v_mov_b32 v115, 0xff800000
  v_mov_b32 v116, 0xff800000
  v_mov_b32 v117, 0xff800000
  v_mov_b32 v118, 0xff800000
  v_mov_b32 v119, 0xff800000
  v_mov_b32 v120, 0xff800000
  v_mov_b32 v121, 0xff800000
  v_mov_b32 v122, 0xff800000
  v_mov_b32 v123, 0xff800000
  v_mov_b32 v124, 0xff800000
  v_mov_b32 v125, 0xff800000
  v_mov_b32 v126, 0xff800000
  v_mov_b32 v127, 0xff800000
  s_cmp_le_u32 s87, 7
  s_cbranch_scc1 L_inv
  v_mov_b32 v128, 0xff800000
  v_mov_b32 v129, 0xff800000
  v_mov_b32 v130, 0xff800000
  v_mov_b32 v131, 0xff800000
  v_mov_b32 v132, 0xff800000
  v_mov_b32 v133, 0xff800000
  v_mov_b32 v134, 0xff800000
  v_mov_b32 v135, 0xff800000
  v_mov_b32 v136, 0xff800000
  v_mov_b32 v137, 0xff800000
  v_mov_b32 v138, 0xff800000
  v_mov_b32 v139, 0xff800000
  v_mov_b32 v140, 0xff800000
  v_mov_b32 v141, 0xff800000
  v_mov_b32 v142, 0xff800000
  v_mov_b32 v143, 0xff800000
L_inv:
  v_cndmask_b32 v16, v144, v16, s[32:33]
  v_cndmask_b32 v17, v145, v17, s[34:35]
  v_cndmask_b32 v18, v146, v18, s[36:37]
  v_cndmask_b32 v19, v147, v19, s[38:39]
  v_cndmask_b32 v20, v148, v20, s[40:41]
  v_cndmask_b32 v21, v149, v21, s[42:43]
  v_cndmask_b32 v22, v150, v22, s[44:45]
  v_cndmask_b32 v23, v151, v23, s[46:47]
  v_cndmask_b32 v24, v152, v24, s[48:49]
  v_cndmask_b32 v25, v153, v25, s[50:51]
  v_cndmask_b32 v26, v154, v26, s[52:53]
  v_cndmask_b32 v27, v155, v27, s[54:55]
  v_cndmask_b32 v28, v156, v28, s[56:57]
  v_cndmask_b32 v29, v157, v29, s[58:59]
  v_cndmask_b32 v30, v158, v30, s[60:61]
  v_cndmask_b32 v31, v159, v31, s[62:63]
  v_max3_f32 v240, v16, v17, v18
  v_max3_f32 v241, v48, v49, v50
  v_max3_f32 v242, v80, v81, v82
  v_max3_f32 v243, v112, v113, v114
  v_max3_f32 v240, v240, v19, v20
  v_max3_f32 v241, v241, v51, v52
  v_max3_f32 v242, v242, v83, v84
  v_max3_f32 v243, v243, v115, v116
  v_max3_f32 v240, v240, v21, v22
  v_max3_f32 v241, v241, v53, v54
  v_max3_f32 v242, v242, v85, v86
  v_max3_f32 v243, v243, v117, v118
  s_cmp_lg_u32 s86, 0
  s_cbranch_scc1 L_interleave_layers__sliding_block__glu_gated_swiglu__prompt_8
  s_add_u32 m0, s22, 0
  s_add_u32 s30, s25, 0
  buffer_load_dwordx4 v1, s[8:11], s30 offen offset:2048 lds
  s_add_u32 m0, s22, 0
  s_add_u32 s30, s25, 0
  buffer_load_dwordx4 v1, s[8:11], s30 offen offset:3072 lds
L_interleave_layers__sliding_block__glu_gated_swiglu__prompt_8:
  v_max3_f32 v240, v240, v23, v24
  v_max3_f32 v241, v241, v55, v56
  v_max3_f32 v242, v242, v87, v88
  v_max3_f32 v243, v243, v119, v120
  v_max3_f32 v240, v240, v25, v26
  v_max3_f32 v241, v241, v57, v58
  v_max3_f32 v242, v242, v89, v90
  v_max3_f32 v243, v243, v121, v122
  v_max3_f32 v240, v240, v27, v28
  v_max3_f32 v241, v241, v59, v60
  v_max3_f32 v242, v242, v91, v92
  v_max3_f32 v243, v243, v123, v124
  v_max3_f32 v240, v240, v29, v30
  v_max3_f32 v241, v241, v61, v62
  v_max3_f32 v242, v242, v93, v94
  v_max3_f32 v243, v243, v125, v126
  s_cmp_lg_u32 s86, 0
  s_cbranch_scc1 L_interleave_layers__sliding_block__glu_gated_swiglu__prompt_9
  s_add_u32 m0, s22, 16384
  s_add_u32 s30, s25, 8192
  buffer_load_dwordx4 v1, s[8:11], s30 offen offset:0 lds
  s_add_u32 m0, s22, 16384
  s_add_u32 s30, s25, 8192
  buffer_load_dwordx4 v1, s[8:11], s30 offen offset:1024 lds
L_interleave_layers__sliding_block__glu_gated_swiglu__prompt_9:
  v_max3_f32 v240, v240, v31, v32
  v_max3_f32 v241, v241, v63, v64
  v_max3_f32 v242, v242, v95, v96
  v_max3_f32 v243, v243, v127, v128
  v_max3_f32 v240, v240, v33, v34
  v_max3_f32 v241, v241, v65, v66
  v_max3_f32 v242, v242, v97, v98
  v_max3_f32 v243, v243, v129, v130
  v_max3_f32 v240, v240, v35, v36
  v_max3_f32 v241, v241, v67, v68
  v_max3_f32 v242, v242, v99, v100
  v_max3_f32 v243, v243, v131, v132
  v_max3_f32 v240, v240, v37, v38
  v_max3_f32 v241, v241, v69, v70
  v_max3_f32 v242, v242, v101, v102
  v_max3_f32 v243, v243, v133, v134
  s_cmp_lg_u32 s86, 0
  s_cbranch_scc1 L_interleave_layers__sliding_block__glu_gated_swiglu__prompt_10
  s_add_u32 m0, s22, 16384
  s_add_u32 s30, s25, 8192
  buffer_load_dwordx4 v1, s[8:11], s30 offen offset:2048 lds
  s_add_u32 m0, s22, 16384
  s_add_u32 s30, s25, 8192
  buffer_load_dwordx4 v1, s[8:11], s30 offen offset:3072 lds
L_interleave_layers__sliding_block__glu_gated_swiglu__prompt_10:
  v_max3_f32 v240, v240, v39, v40
  v_max3_f32 v241, v241, v71, v72
  v_max3_f32 v242, v242, v103, v104
  v_max3_f32 v243, v243, v135, v136
  v_max3_f32 v240, v240, v41, v42
  v_max3_f32 v241, v241, v73, v74
  v_max3_f32 v242, v242, v105, v106
  v_max3_f32 v243, v243, v137, v138
  v_max3_f32 v240, v240, v43, v44
  v_max3_f32 v241, v241, v75, v76
  v_max3_f32 v242, v242, v107, v108
  v_max3_f32 v243, v243, v139, v140
  v_max3_f32 v240, v240, v45, v46
  v_max3_f32 v241, v241, v77, v78
  v_max3_f32 v242, v242, v109, v110
  v_max3_f32 v243, v243, v141, v142
  s_cmp_lg_u32 s86, 0
  s_cbranch_scc1 L_interleave_layers__sliding_block__glu_gated_swiglu__prompt_11
  s_add_u32 m0, s22, 32768
  s_add_u32 s30, s25, 16384
  buffer_load_dwordx4 v1, s[8:11], s30 offen offset:0 lds
  s_add_u32 m0, s22, 32768
  s_add_u32 s30, s25, 16384
  buffer_load_dwordx4 v1, s[8:11], s30 offen offset:1024 lds
L_interleave_layers__sliding_block__glu_gated_swiglu__prompt_11:
  v_max_f32 v240, v240, v47
  v_max_f32 v241, v241, v79
  v_max_f32 v242, v242, v111
  v_max_f32 v243, v243, v143
  v_max3_f32 v240, v240, v241, v242
  v_max_f32 v240, v240, v243
  v_mov_b32 v241, v240
  s_nop 1
  v_permlane32_swap_b32 v240, v241
  s_nop 1
  v_max_f32 v240, v240, v241
  v_sub_f32 v144, 0, v240
  v_sub_f32 v145, 0, v240
  v_pk_mov_b32 v[146:147], v[144:145], v[144:145] op_sel:[0,1]
  v_pk_mov_b32 v[148:149], v[144:145], v[144:145] op_sel:[0,1]
  v_pk_mov_b32 v[150:151], v[144:145], v[144:145] op_sel:[0,1]
  v_pk_mov_b32 v[152:153], v[144:145], v[144:145] op_sel:[0,1]
  v_pk_mov_b32 v[154:155], v[144:145], v[144:145] op_sel:[0,1]
  v_pk_mov_b32 v[156:157], v[144:145], v[144:145] op_sel:[0,1]
  v_pk_mov_b32 v[158:159], v[144:145], v[144:145] op_sel:[0,1]
  s_mov_b64 exec, s[88:89]
  ds_read_b128 v[216:219], v10 offset:2048
  ds_read_b128 v[220:223], v10 offset:3072
  s_mov_b64 exec, -1
  v_mfma_f32_32x32x16_bf16 v[48:63], v[188:191], v[196:199], v[144:159]
  v_mfma_f32_32x32x16_bf16 v[32:47], v[184:187], v[196:199], v[144:159]
  v_pk_add_f32 v[16:17], v[16:17], v[144:145] op_sel:[0,0] op_sel_hi:[1,1]
  v_pk_add_f32 v[18:19], v[18:19], v[144:145] op_sel:[0,0] op_sel_hi:[1,1]
  v_pk_add_f32 v[20:21], v[20:21], v[144:145] op_sel:[0,0] op_sel_hi:[1,1]
  v_pk_add_f32 v[22:23], v[22:23], v[144:145] op_sel:[0,0] op_sel_hi:[1,1]
  v_pk_add_f32 v[24:25], v[24:25], v[144:145] op_sel:[0,0] op_sel_hi:[1,1]
  v_pk_add_f32 v[26:27], v[26:27], v[144:145] op_sel:[0,0] op_sel_hi:[1,1]
  v_pk_add_f32 v[28:29], v[28:29], v[144:145] op_sel:[0,0] op_sel_hi:[1,1]
  v_pk_add_f32 v[30:31], v[30:31], v[144:145] op_sel:[0,0] op_sel_hi:[1,1]
  v_exp_f32 v16, v16
  v_exp_f32 v17, v17
  s_cmp_lg_u32 s86, 0
  s_cbranch_scc1 L_interleave_layers__sliding_block__glu_gated_swiglu__prompt_12
  s_add_u32 m0, s22, 32768
  s_add_u32 s30, s25, 16384
  buffer_load_dwordx4 v1, s[8:11], s30 offen offset:2048 lds
  s_add_u32 m0, s22, 32768
  s_add_u32 s30, s25, 16384
  buffer_load_dwordx4 v1, s[8:11], s30 offen offset:3072 lds
L_interleave_layers__sliding_block__glu_gated_swiglu__prompt_12:
  v_exp_f32 v18, v18
  v_exp_f32 v19, v19
  s_cmp_lg_u32 s86, 0
  s_cbranch_scc1 L_interleave_layers__sliding_block__glu_gated_swiglu__prompt_13
  s_add_u32 m0, s22, 49152
  s_add_u32 s30, s25, 24576
  buffer_load_dwordx4 v1, s[8:11], s30 offen offset:0 lds
  s_add_u32 m0, s22, 49152
  s_add_u32 s30, s25, 24576
  buffer_load_dwordx4 v1, s[8:11], s30 offen offset:1024 lds
L_interleave_layers__sliding_block__glu_gated_swiglu__prompt_13:
  v_exp_f32 v20, v20
  v_exp_f32 v21, v21
  s_cmp_lg_u32 s86, 0
  s_cbranch_scc1 L_interleave_layers__sliding_block__glu_gated_swiglu__prompt_14
  s_add_u32 m0, s22, 49152
  s_add_u32 s30, s25, 24576
  buffer_load_dwordx4 v1, s[8:11], s30 offen offset:2048 lds
  s_add_u32 m0, s22, 49152
  s_add_u32 s30, s25, 24576
  buffer_load_dwordx4 v1, s[8:11], s30 offen offset:3072 lds
L_interleave_layers__sliding_block__glu_gated_swiglu__prompt_14:
  v_exp_f32 v22, v22
  v_exp_f32 v23, v23
  s_cmp_lg_u32 s86, 0
  s_cbranch_scc1 L_interleave_layers__sliding_block__glu_gated_swiglu__prompt_15
  s_add_u32 m0, s22, 65536
  s_add_u32 s30, s91, 0
  buffer_load_dwordx4 v1, s[8:11], s30 offen offset:0 lds
  s_add_u32 m0, s22, 65536
  s_add_u32 s30, s91, 0
  buffer_load_dwordx4 v1, s[8:11], s30 offen offset:1024 lds
L_interleave_layers__sliding_block__glu_gated_swiglu__prompt_15:
  v_exp_f32 v24, v24
  v_exp_f32 v25, v25
  s_cmp_lg_u32 s86, 0
  s_cbranch_scc1 L_interleave_layers__sliding_block__glu_gated_swiglu__prompt_16
  s_add_u32 m0, s22, 65536
  s_add_u32 s30, s91, 0
  buffer_load_dwordx4 v1, s[8:11], s30 offen offset:2048 lds
  s_add_u32 m0, s22, 65536
  s_add_u32 s30, s91, 0
  buffer_load_dwordx4 v1, s[8:11], s30 offen offset:3072 lds
L_interleave_layers__sliding_block__glu_gated_swiglu__prompt_16:
  v_exp_f32 v26, v26
  v_exp_f32 v27, v27
  s_cmp_lg_u32 s86, 0
  s_cbranch_scc1 L_interleave_layers__sliding_block__glu_gated_swiglu__prompt_17
  s_add_u32 m0, s22, 81920
  s_add_u32 s30, s91, 8192
  buffer_load_dwordx4 v1, s[8:11], s30 offen offset:0 lds
  s_add_u32 m0, s22, 81920
  s_add_u32 s30, s91, 8192
  buffer_load_dwordx4 v1, s[8:11], s30 offen offset:1024 lds
L_interleave_layers__sliding_block__glu_gated_swiglu__prompt_17:
  v_exp_f32 v28, v28
  v_exp_f32 v29, v29
  s_cmp_lg_u32 s86, 0
  s_cbranch_scc1 L_interleave_layers__sliding_block__glu_gated_swiglu__prompt_18
  s_add_u32 m0, s22, 81920
  s_add_u32 s30, s91, 8192
  buffer_load_dwordx4 v1, s[8:11], s30 offen offset:2048 lds
  s_add_u32 m0, s22, 81920
  s_add_u32 s30, s91, 8192
  buffer_load_dwordx4 v1, s[8:11], s30 offen offset:3072 lds
  s_cmp_eq_u32 s20, 0
  s_cbranch_scc1 L_pf5
  s_lshl_b32 s28, s21, 15
  s_and_b32 s29, s16, 1
  s_mul_i32 s29, s29, 65536
  s_add_u32 s28, s28, s29
  s_mul_i32 s29, s18, 16384
  s_add_u32 s28, s28, s29
  s_add_u32 s28, s28, 0x4200000
  s_cmp_eq_u32 s17, 15
  s_cselect_b32 s28, 0x40000000, s28
  v_lshlrev_b32 v6, 7, v0
  buffer_load_dword v244, v6, s[8:11], s28 offen
  s_add_u32 s28, s28, 8192
  buffer_load_dword v245, v6, s[8:11], s28 offen
  s_add_u32 s28, s28, 8192
L_pf5:
L_interleave_layers__sliding_block__glu_gated_swiglu__prompt_18:
  v_exp_f32 v30, v30
  v_exp_f32 v31, v31
  v_cvt_pk_bf16_f32 v80, v16, v17
  v_cvt_pk_bf16_f32 v81, v18, v19
  v_cvt_pk_bf16_f32 v82, v20, v21
  v_cvt_pk_bf16_f32 v83, v22, v23
  v_cvt_pk_bf16_f32 v84, v24, v25
  v_cvt_pk_bf16_f32 v85, v26, v27
  v_cvt_pk_bf16_f32 v86, v28, v29
  v_cvt_pk_bf16_f32 v87, v30, v31
  v_bfi_b32 v88, v232, 0, v80
  v_bfi_b32 v89, v233, 0, v81
  v_bfi_b32 v90, v234, 0, v82
  v_bfi_b32 v91, v235, 0, v83
  v_bfi_b32 v92, v236, 0, v84
  v_bfi_b32 v93, v237, 0, v85
  v_bfi_b32 v94, v238, 0, v86
  v_bfi_b32 v95, v239, 0, v87
  v_and_b32 v80, v232, v80
  v_and_b32 v81, v233, v81
  v_and_b32 v82, v234, v82
  v_and_b32 v83, v235, v83
  v_and_b32 v84, v236, v84
  v_and_b32 v85, v237, v85
  v_and_b32 v86, v238, v86
  v_and_b32 v87, v239, v87
  s_mov_b64 exec, s[88:89]
  ds_read_b128 v[224:227], v10 offset:34816
  ds_read_b128 v[228:231], v10 offset:35840
  s_mov_b64 exec, -1
  s_waitcnt lgkmcnt(2)
  v_mfma_f32_32x32x16_bf16 v[200:215], v[216:219], v[80:83], 0
  v_mfma_f32_32x32x16_bf16 v[200:215], v[220:223], v[84:87], v[200:215]
  s_mov_b64 exec, s[88:89]
  ds_read_b128 v[216:219], v10 offset:30720
  ds_read_b128 v[220:223], v10 offset:31744
  s_mov_b64 exec, -1
  s_waitcnt lgkmcnt(2)
  v_mfma_f32_32x32x16_bf16 v[200:215], v[224:227], v[88:91], v[200:215]
  v_mfma_f32_32x32x16_bf16 v[200:215], v[228:231], v[92:95], v[200:215]
  s_cmp_gt_u32 s87, 7
  s_cbranch_scc1 L_pvdone
  v_mfma_f32_32x32x16_bf16 v[64:79], v[180:183], v[196:199], v[144:159]
  v_exp_f32 v48, v48
  v_exp_f32 v49, v49
  v_exp_f32 v50, v50
  v_exp_f32 v51, v51
  v_exp_f32 v52, v52
  v_exp_f32 v53, v53
  v_exp_f32 v54, v54
  v_exp_f32 v55, v55
  v_exp_f32 v56, v56
  v_exp_f32 v57, v57
  v_exp_f32 v58, v58
  v_exp_f32 v59, v59
  v_exp_f32 v60, v60
  v_exp_f32 v61, v61
  v_exp_f32 v62, v62
  v_exp_f32 v63, v63
  v_cvt_pk_bf16_f32 v96, v48, v49
  v_cvt_pk_bf16_f32 v97, v50, v51
  v_cvt_pk_bf16_f32 v98, v52, v53
  v_cvt_pk_bf16_f32 v99, v54, v55
  v_cvt_pk_bf16_f32 v100, v56, v57
  v_cvt_pk_bf16_f32 v101, v58, v59
  v_cvt_pk_bf16_f32 v102, v60, v61
  v_cvt_pk_bf16_f32 v103, v62, v63
  s_mov_b64 exec, s[88:89]
  ds_read_b128 v[224:227], v10 offset:26624
  ds_read_b128 v[228:231], v10 offset:27648
  s_mov_b64 exec, -1
  s_waitcnt lgkmcnt(2)
  v_mfma_f32_32x32x16_bf16 v[200:215], v[216:219], v[96:99], v[200:215]
  v_mfma_f32_32x32x16_bf16 v[200:215], v[220:223], v[100:103], v[200:215]
  s_cmp_gt_u32 s87, 6
  s_cbranch_scc1 L_pvdone
  v_mfma_f32_32x32x16_bf16 v[48:63], v[176:179], v[196:199], v[144:159]
  v_exp_f32 v32, v32
  v_exp_f32 v33, v33
  v_exp_f32 v34, v34
  v_exp_f32 v35, v35
  v_exp_f32 v36, v36
  v_exp_f32 v37, v37
  v_exp_f32 v38, v38
  v_exp_f32 v39, v39
  v_exp_f32 v40, v40
  v_exp_f32 v41, v41
  v_exp_f32 v42, v42
  v_exp_f32 v43, v43
  v_exp_f32 v44, v44
  v_exp_f32 v45, v45
  v_exp_f32 v46, v46
  v_exp_f32 v47, v47
  v_cvt_pk_bf16_f32 v80, v32, v33
  v_cvt_pk_bf16_f32 v81, v34, v35
  v_cvt_pk_bf16_f32 v82, v36, v37
  v_cvt_pk_bf16_f32 v83, v38, v39
  v_cvt_pk_bf16_f32 v84, v40, v41
  v_cvt_pk_bf16_f32 v85, v42, v43
  v_cvt_pk_bf16_f32 v86, v44, v45
  v_cvt_pk_bf16_f32 v87, v46, v47
  s_mov_b64 exec, s[88:89]
  ds_read_b128 v[216:219], v10 offset:22528
  ds_read_b128 v[220:223], v10 offset:23552
  s_mov_b64 exec, -1
  s_waitcnt lgkmcnt(2)
  v_mfma_f32_32x32x16_bf16 v[200:215], v[224:227], v[80:83], v[200:215]
  v_mfma_f32_32x32x16_bf16 v[200:215], v[228:231], v[84:87], v[200:215]
  s_cmp_gt_u32 s87, 5
  s_cbranch_scc1 L_pvdone
  v_mfma_f32_32x32x16_bf16 v[32:47], v[172:175], v[196:199], v[144:159]
  v_exp_f32 v64, v64
  v_exp_f32 v65, v65
  v_exp_f32 v66, v66
  v_exp_f32 v67, v67
  v_exp_f32 v68, v68
  v_exp_f32 v69, v69
  v_exp_f32 v70, v70
  v_exp_f32 v71, v71
  v_exp_f32 v72, v72
  v_exp_f32 v73, v73
  v_exp_f32 v74, v74
  v_exp_f32 v75, v75
  v_exp_f32 v76, v76
  v_exp_f32 v77, v77
  v_exp_f32 v78, v78
  v_exp_f32 v79, v79
  v_cvt_pk_bf16_f32 v88, v64, v65
  v_cvt_pk_bf16_f32 v89, v66, v67
  v_cvt_pk_bf16_f32 v90, v68, v69
  v_cvt_pk_bf16_f32 v91, v70, v71
  v_cvt_pk_bf16_f32 v92, v72, v73
  v_cvt_pk_bf16_f32 v93, v74, v75
  v_cvt_pk_bf16_f32 v94, v76, v77
  v_cvt_pk_bf16_f32 v95, v78, v79
  s_mov_b64 exec, s[88:89]
  ds_read_b128 v[224:227], v10 offset:18432
  ds_read_b128 v[228:231], v10 offset:19456
  s_mov_b64 exec, -1
  s_waitcnt lgkmcnt(2)
  v_mfma_f32_32x32x16_bf16 v[200:215], v[216:219], v[88:91], v[200:215]
  v_mfma_f32_32x32x16_bf16 v[200:215], v[220:223], v[92:95], v[200:215]
  s_cmp_gt_u32 s87, 4
  s_cbranch_scc1 L_pvdone
  v_mfma_f32_32x32x16_bf16 v[64:79], v[168:171], v[196:199], v[144:159]
  v_exp_f32 v48, v48
  v_exp_f32 v49, v49
  v_exp_f32 v50, v50
  v_exp_f32 v51, v51
  v_exp_f32 v52, v52
  v_exp_f32 v53, v53
  v_exp_f32 v54, v54
  v_exp_f32 v55, v55
  v_exp_f32 v56, v56
  v_exp_f32 v57, v57
  v_exp_f32 v58, v58
  v_exp_f32 v59, v59
  v_exp_f32 v60, v60
  v_exp_f32 v61, v61
  v_exp_f32 v62, v62
  v_exp_f32 v63, v63
  v_cvt_pk_bf16_f32 v96, v48, v49
  v_cvt_pk_bf16_f32 v97, v50, v51
  v_cvt_pk_bf16_f32 v98, v52, v53
  v_cvt_pk_bf16_f32 v99, v54, v55
  v_cvt_pk_bf16_f32 v100, v56, v57
  v_cvt_pk_bf16_f32 v101, v58, v59
  v_cvt_pk_bf16_f32 v102, v60, v61
  v_cvt_pk_bf16_f32 v103, v62, v63
  s_mov_b64 exec, s[88:89]
  ds_read_b128 v[216:219], v10 offset:14336
  ds_read_b128 v[220:223], v10 offset:15360
  s_mov_b64 exec, -1
  s_waitcnt lgkmcnt(2)
  v_mfma_f32_32x32x16_bf16 v[200:215], v[224:227], v[96:99], v[200:215]
  v_mfma_f32_32x32x16_bf16 v[200:215], v[228:231], v[100:103], v[200:215]
  s_cmp_gt_u32 s87, 3
  s_cbranch_scc1 L_pvdone
  v_mfma_f32_32x32x16_bf16 v[48:63], v[164:167], v[196:199], v[144:159]
  v_exp_f32 v32, v32
  v_exp_f32 v33, v33
  v_exp_f32 v34, v34
  v_exp_f32 v35, v35
  v_exp_f32 v36, v36
  v_exp_f32 v37, v37
  v_exp_f32 v38, v38
  v_exp_f32 v39, v39
  v_exp_f32 v40, v40
  v_exp_f32 v41, v41
  v_exp_f32 v42, v42
  v_exp_f32 v43, v43
  v_exp_f32 v44, v44
  v_exp_f32 v45, v45
  v_exp_f32 v46, v46
  v_exp_f32 v47, v47
  v_cvt_pk_bf16_f32 v80, v32, v33
  v_cvt_pk_bf16_f32 v81, v34, v35
  v_cvt_pk_bf16_f32 v82, v36, v37
  v_cvt_pk_bf16_f32 v83, v38, v39
  v_cvt_pk_bf16_f32 v84, v40, v41
  v_cvt_pk_bf16_f32 v85, v42, v43
  v_cvt_pk_bf16_f32 v86, v44, v45
  v_cvt_pk_bf16_f32 v87, v46, v47
  s_mov_b64 exec, s[88:89]
  ds_read_b128 v[224:227], v10 offset:10240
  ds_read_b128 v[228:231], v10 offset:11264
  s_mov_b64 exec, -1
  s_waitcnt lgkmcnt(2)
  v_mfma_f32_32x32x16_bf16 v[200:215], v[216:219], v[80:83], v[200:215]
  v_mfma_f32_32x32x16_bf16 v[200:215], v[220:223], v[84:87], v[200:215]
  s_cmp_gt_u32 s87, 2
  s_cbranch_scc1 L_pvdone
  v_exp_f32 v64, v64
  v_exp_f32 v65, v65
  v_exp_f32 v66, v66
  v_exp_f32 v67, v67
  v_exp_f32 v68, v68
  v_exp_f32 v69, v69
  v_exp_f32 v70, v70
  v_exp_f32 v71, v71
  v_exp_f32 v72, v72
  v_exp_f32 v73, v73
  v_exp_f32 v74, v74
  v_exp_f32 v75, v75
  v_exp_f32 v76, v76
  v_exp_f32 v77, v77
  v_exp_f32 v78, v78
  v_exp_f32 v79, v79
  v_cvt_pk_bf16_f32 v88, v64, v65
  v_cvt_pk_bf16_f32 v89, v66, v67
  v_cvt_pk_bf16_f32 v90, v68, v69
  v_cvt_pk_bf16_f32 v91, v70, v71
  v_cvt_pk_bf16_f32 v92, v72, v73
  v_cvt_pk_bf16_f32 v93, v74, v75
  v_cvt_pk_bf16_f32 v94, v76, v77
  v_cvt_pk_bf16_f32 v95, v78, v79
  s_mov_b64 exec, s[88:89]
  ds_read_b128 v[216:219], v10 offset:6144
  ds_read_b128 v[220:223], v10 offset:7168
  s_mov_b64 exec, -1
  s_waitcnt lgkmcnt(2)
  v_mfma_f32_32x32x16_bf16 v[200:215], v[224:227], v[88:91], v[200:215]
  v_mfma_f32_32x32x16_bf16 v[200:215], v[228:231], v[92:95], v[200:215]
  s_cmp_gt_u32 s87, 1
  s_cbranch_scc1 L_pvdone
  v_exp_f32 v48, v48
  v_exp_f32 v49, v49
  v_exp_f32 v50, v50
  v_exp_f32 v51, v51
  v_exp_f32 v52, v52
  v_exp_f32 v53, v53
  v_exp_f32 v54, v54
  v_exp_f32 v55, v55
  v_exp_f32 v56, v56
  v_exp_f32 v57, v57
  v_exp_f32 v58, v58
  v_exp_f32 v59, v59
  v_exp_f32 v60, v60
  v_exp_f32 v61, v61
  v_exp_f32 v62, v62
  v_exp_f32 v63, v63
  v_cvt_pk_bf16_f32 v96, v48, v49
  v_cvt_pk_bf16_f32 v97, v50, v51
  v_cvt_pk_bf16_f32 v98, v52, v53
  v_cvt_pk_bf16_f32 v99, v54, v55
  v_cvt_pk_bf16_f32 v100, v56, v57
  v_cvt_pk_bf16_f32 v101, v58, v59
  v_cvt_pk_bf16_f32 v102, v60, v61
  v_cvt_pk_bf16_f32 v103, v62, v63
  s_waitcnt lgkmcnt(0)
  s_nop 0
  v_mfma_f32_32x32x16_bf16 v[200:215], v[216:219], v[96:99], v[200:215]
  v_mfma_f32_32x32x16_bf16 v[200:215], v[220:223], v[100:103], v[200:215]
L_pvdone:
  s_waitcnt lgkmcnt(0)
  s_lshl_b32 s28, s19, 5
  s_lshl_b32 s29, s17, 1
  s_add_u32 s28, s28, s29
  s_add_u32 s28, s28, s86
  s_and_b32 s29, s28, 31
  s_lshl_b32 s29, s29, 2
  s_lshl_b32 s30, s19, 12
  s_add_u32 s29, s29, s30
  s_lshl_b32 s28, s28, 10
  s_add_u32 s28, s28, 0x400000
  s_add_u32 s29, s29, 0x10c0000
  s_nop 5
  s_cmp_lg_u32 s86, 0
  s_cbranch_scc1 L_hb
  v_rcp_f32 v7, v208
  s_nop 0
  v_pk_mul_f32 v[16:17], v[200:201], v[6:7] op_sel:[0,1] op_sel_hi:[1,1]
  v_pk_mul_f32 v[18:19], v[202:203], v[6:7] op_sel:[0,1] op_sel_hi:[1,1]
  v_pk_mul_f32 v[20:21], v[204:205], v[6:7] op_sel:[0,1] op_sel_hi:[1,1]
  v_pk_mul_f32 v[22:23], v[206:207], v[6:7] op_sel:[0,1] op_sel_hi:[1,1]
  s_branch L_hfin
L_hb:
  v_rcp_f32 v7, v200
  s_nop 0
  v_pk_mul_f32 v[16:17], v[208:209], v[6:7] op_sel:[0,1] op_sel_hi:[1,1]
  v_pk_mul_f32 v[18:19], v[210:211], v[6:7] op_sel:[0,1] op_sel_hi:[1,1]
  v_pk_mul_f32 v[20:21], v[212:213], v[6:7] op_sel:[0,1] op_sel_hi:[1,1]
  v_pk_mul_f32 v[22:23], v[214:215], v[6:7] op_sel:[0,1] op_sel_hi:[1,1]
L_hfin:
  v_cvt_pk_bf16_f32 v24, v16, v17
  v_cvt_pk_bf16_f32 v25, v18, v19
  v_cvt_pk_bf16_f32 v26, v20, v21
  v_cvt_pk_bf16_f32 v27, v22, v23
  s_cmp_eq_u32 s101, 1
  s_cbranch_scc1 L_interleave_layers__sliding_block__glu_gated_swiglu__prompt_19
  buffer_store_dwordx4 v[24:27], v1, s[12:15], s28 offen sc1
  s_branch L_interleave_layers__sliding_block__glu_gated_swiglu__prompt_20
L_interleave_layers__sliding_block__glu_gated_swiglu__prompt_19:
  buffer_store_dwordx4 v[24:27], v1, s[12:15], s28 offen
L_interleave_layers__sliding_block__glu_gated_swiglu__prompt_20:
  v_mov_b32 v7, s98
  v_mov_b32 v8, 0
  s_waitcnt vmcnt(0)
  s_mov_b64 exec, 1
  s_cmp_eq_u32 s101, 1
  s_cbranch_scc1 L_interleave_layers__sliding_block__glu_gated_swiglu__prompt_21
  buffer_store_dword v7, v8, s[12:15], s29 offen sc1
  s_branch L_interleave_layers__sliding_block__glu_gated_swiglu__prompt_22
L_interleave_layers__sliding_block__glu_gated_swiglu__prompt_21:
  buffer_store_dword v7, v8, s[12:15], s29 offen
L_interleave_layers__sliding_block__glu_gated_swiglu__prompt_22:
  s_mov_b64 exec, -1
  s_barrier
  s_cmp_ge_u32 s3, 4
  s_cbranch_scc1 L_LP2
  s_setprio 0
  s_add_u32 m0, s22, 114688
  s_add_u32 s30, s99, 16384
  s_and_b32 s30, s30, 0x7fff
  s_add_u32 s30, s30, s26
  buffer_load_dwordx4 v1, s[8:11], s30 offen offset:0  lds
  buffer_load_dwordx4 v1, s[8:11], s30 offen offset:1024  lds
  buffer_load_dwordx4 v1, s[8:11], s30 offen offset:2048  lds
  buffer_load_dwordx4 v1, s[8:11], s30 offen offset:3072  lds
  s_add_u32 m0, s22, 131072
  s_add_u32 s30, s99, 24576
  s_and_b32 s30, s30, 0x7fff
  s_add_u32 s30, s30, s26
  buffer_load_dwordx4 v1, s[8:11], s30 offen offset:0  lds
  buffer_load_dwordx4 v1, s[8:11], s30 offen offset:1024  lds
  buffer_load_dwordx4 v1, s[8:11], s30 offen offset:2048  lds
  buffer_load_dwordx4 v1, s[8:11], s30 offen offset:3072  lds
  s_add_u32 m0, s22, 147456
  s_add_u32 s30, s99, 0
  s_and_b32 s30, s30, 0x7fff
  s_add_u32 s30, s30, s26
  s_add_u32 s30, s30, 65536
  buffer_load_dwordx4 v1, s[8:11], s30 offen offset:0  lds
  buffer_load_dwordx4 v1, s[8:11], s30 offen offset:1024  lds
  buffer_load_dwordx4 v1, s[8:11], s30 offen offset:2048  lds
  buffer_load_dwordx4 v1, s[8:11], s30 offen offset:3072  lds
  s_lshl_b32 s28, s21, 10
  s_add_u32 s28, s28, 0x4690000
  s_add_u32 s29, s28, 4096
  buffer_load_dwordx4 v[96:99], v1, s[8:11], s28 offen offset:0
  buffer_load_dwordx4 v[100:103], v1, s[8:11], s28 offen offset:1024
  buffer_load_dwordx4 v[104:107], v1, s[8:11], s28 offen offset:2048
  buffer_load_dwordx4 v[108:111], v1, s[8:11], s28 offen offset:3072
  buffer_load_dwordx4 v[112:115], v1, s[8:11], s29 offen offset:0
  buffer_load_dwordx4 v[116:119], v1, s[8:11], s29 offen offset:1024
  s_barrier
  s_barrier
  s_add_u32 m0, s22, 0
  s_add_u32 s30, s99, 8192
  s_and_b32 s30, s30, 0x7fff
  s_add_u32 s30, s30, s26
  s_add_u32 s30, s30, 65536
  buffer_load_dwordx4 v1, s[8:11], s30 offen offset:0  lds
  buffer_load_dwordx4 v1, s[8:11], s30 offen offset:1024  lds
  buffer_load_dwordx4 v1, s[8:11], s30 offen offset:2048  lds
  buffer_load_dwordx4 v1, s[8:11], s30 offen offset:3072  lds
  s_add_u32 m0, s22, 16384
  s_add_u32 s30, s99, 16384
  s_and_b32 s30, s30, 0x7fff
  s_add_u32 s30, s30, s26
  s_add_u32 s30, s30, 65536
  buffer_load_dwordx4 v1, s[8:11], s30 offen offset:0  lds
  buffer_load_dwordx4 v1, s[8:11], s30 offen offset:1024  lds
  buffer_load_dwordx4 v1, s[8:11], s30 offen offset:2048  lds
  buffer_load_dwordx4 v1, s[8:11], s30 offen offset:3072  lds
  s_add_u32 m0, s22, 32768
  s_add_u32 s30, s99, 24576
  s_and_b32 s30, s30, 0x7fff
  s_add_u32 s30, s30, s26
  s_add_u32 s30, s30, 65536
  buffer_load_dwordx4 v1, s[8:11], s30 offen offset:0  lds
  buffer_load_dwordx4 v1, s[8:11], s30 offen offset:1024  lds
  buffer_load_dwordx4 v1, s[8:11], s30 offen offset:2048  lds
  buffer_load_dwordx4 v1, s[8:11], s30 offen offset:3072  lds
  v_and_b32 v3, 15, v0
  v_lshlrev_b32 v3, 2, v3
  s_lshl_b32 s29, s19, 11
  s_add_u32 s28, s29, 0x1080000
  s_mov_b32 s31, 0
L_interleave_layers__sliding_block__glu_gated_swiglu__prompt_23:
  buffer_load_dword v6, v3, s[12:15], s28 offen sc1
  s_waitcnt vmcnt(0)
  v_cmp_eq_u32 vcc, s98, v6
  s_nop 1
  s_cmp_eq_u64 vcc, -1
  s_cbranch_scc1 L_interleave_layers__sliding_block__glu_gated_swiglu__prompt_24
  s_add_u32 s31, s31, 1
  s_cmp_lt_u32 s31, 0x20000
  s_cbranch_scc1 L_interleave_layers__sliding_block__glu_gated_swiglu__prompt_23
L_interleave_layers__sliding_block__glu_gated_swiglu__prompt_24:
  s_mul_i32 s91, s19, 90112
  s_lshl_b32 s28, s17, 11
  s_add_u32 s91, s91, s28
  s_add_u32 s91, s91, 0xa00000
  s_lshl_b32 s90, s19, 15
  s_add_u32 s90, s90, 0x0
  s_lshl_b32 s29, s19, 12
  s_add_u32 s29, s29, 0xf80000
  buffer_load_dwordx4 v[48:51], v1, s[12:15], s29 offen offset:0 sc1
  buffer_load_dwordx4 v[52:55], v1, s[12:15], s29 offen offset:1024 sc1
  buffer_load_dwordx4 v[56:59], v1, s[12:15], s29 offen offset:2048 sc1
  buffer_load_dwordx4 v[60:63], v1, s[12:15], s29 offen offset:3072 sc1
  s_add_u32 s28, s90, 0
  buffer_load_dwordx4 v[128:131], v1, s[12:15], s28 offen offset:0 sc1
  buffer_load_dwordx4 v[132:135], v1, s[12:15], s28 offen offset:1024 sc1
  buffer_load_dwordx4 v[136:139], v1, s[12:15], s28 offen offset:2048 sc1
  buffer_load_dwordx4 v[140:143], v1, s[12:15], s28 offen offset:3072 sc1
  s_add_u32 s28, s90, 4096
  buffer_load_dwordx4 v[144:147], v1, s[12:15], s28 offen offset:0 sc1
  buffer_load_dwordx4 v[148:151], v1, s[12:15], s28 offen offset:1024 sc1
  buffer_load_dwordx4 v[152:155], v1, s[12:15], s28 offen offset:2048 sc1
  buffer_load_dwordx4 v[156:159], v1, s[12:15], s28 offen offset:3072 sc1
  s_waitcnt vmcnt(12)
  s_barrier
  s_add_u32 s28, s90, 8192
  buffer_load_dwordx4 v[160:163], v1, s[12:15], s28 offen offset:0 sc1
  buffer_load_dwordx4 v[164:167], v1, s[12:15], s28 offen offset:1024 sc1
  buffer_load_dwordx4 v[168:171], v1, s[12:15], s28 offen offset:2048 sc1
  buffer_load_dwordx4 v[172:175], v1, s[12:15], s28 offen offset:3072 sc1
  s_add_u32 s28, s90, 12288
  buffer_load_dwordx4 v[176:179], v1, s[12:15], s28 offen offset:0 sc1
  buffer_load_dwordx4 v[180:183], v1, s[12:15], s28 offen offset:1024 sc1
  buffer_load_dwordx4 v[184:187], v1, s[12:15], s28 offen offset:2048 sc1
  buffer_load_dwordx4 v[188:191], v1, s[12:15], s28 offen offset:3072 sc1
  s_waitcnt vmcnt(16)
  v_pk_add_f32 v[48:49], v[48:49], v[56:57]
  v_pk_add_f32 v[50:51], v[50:51], v[58:59]
  v_pk_add_f32 v[52:53], v[52:53], v[60:61]
  v_pk_add_f32 v[54:55], v[54:55], v[62:63]
  v_pk_add_f32 v[48:49], v[48:49], v[52:53]
  v_pk_add_f32 v[50:51], v[50:51], v[54:55]
  v_pk_add_f32 v[48:49], v[48:49], v[50:51]
  v_add_f32 v48, v48, v49
  v_mov_b32 v49, v48
  s_nop 1
  v_permlane32_swap_b32 v48, v49
  s_nop 1
  v_mul_f32 v48, 0xbb000000, v48
  v_mul_f32 v49, 0x3b000000, v49
  v_fma_f32 v49, -v48, v48, v49
  v_max_f32 v49, 0, v49
  v_add_f32 v10, 0x3727c5ac, v49
  v_rsq_f32 v11, v10
  v_cvt_pk_bf16_f32 v50, v48, v48
  v_and_b32 v50, 0xffff0000, v50
  v_sub_f32 v51, v48, v50
  v_cvt_pk_bf16_f32 v12, v50, v51
  v_mov_b32 v13, v12
  v_mov_b32 v14, v12
  v_mov_b32 v15, v12
  v_mul_f32 v9, 0xbfb8aa3b, v11
  ds_read_b128 v[80:83], v4 offset:4096
  ds_read_b128 v[84:87], v4 offset:8192
  v_mfma_f32_32x32x16_bf16 v[16:31], v[96:99], v[12:15], 0
  v_mfma_f32_32x32x16_bf16 v[32:47], v[100:103], v[12:15], 0
  s_add_u32 s28, s90, 16384
  buffer_load_dwordx4 v[192:195], v1, s[12:15], s28 offen offset:0 sc1
  ds_read_b128 v[88:91], v4 offset:5120
  ds_read_b128 v[92:95], v4 offset:9216
  s_waitcnt vmcnt(16) lgkmcnt(2)
  v_mfma_f32_32x32x16_bf16 v[16:31], v[80:83], v[128:131], v[16:31]
  v_mfma_f32_32x32x16_bf16 v[32:47], v[84:87], v[128:131], v[32:47]
  buffer_load_dwordx4 v[196:199], v1, s[12:15], s28 offen offset:1024 sc1
  ds_read_b128 v[80:83], v4 offset:6144
  ds_read_b128 v[84:87], v4 offset:10240
  s_waitcnt vmcnt(16) lgkmcnt(2)
  v_mfma_f32_32x32x16_bf16 v[16:31], v[88:91], v[132:135], v[16:31]
  v_mfma_f32_32x32x16_bf16 v[32:47], v[92:95], v[132:135], v[32:47]
  buffer_load_dwordx4 v[200:203], v1, s[12:15], s28 offen offset:2048 sc1
  ds_read_b128 v[88:91], v4 offset:7168
  ds_read_b128 v[92:95], v4 offset:11264
  s_waitcnt vmcnt(16) lgkmcnt(2)
  v_mfma_f32_32x32x16_bf16 v[16:31], v[80:83], v[136:139], v[16:31]
  v_mfma_f32_32x32x16_bf16 v[32:47], v[84:87], v[136:139], v[32:47]
  buffer_load_dwordx4 v[204:207], v1, s[12:15], s28 offen offset:3072 sc1
  ds_read_b128 v[80:83], v4 offset:12288
  ds_read_b128 v[84:87], v4 offset:16384
  s_waitcnt vmcnt(16) lgkmcnt(2)
  v_mfma_f32_32x32x16_bf16 v[16:31], v[88:91], v[140:143], v[16:31]
  v_mfma_f32_32x32x16_bf16 v[32:47], v[92:95], v[140:143], v[32:47]
  s_add_u32 s28, s90, 20480
  buffer_load_dwordx4 v[208:211], v1, s[12:15], s28 offen offset:0 sc1
  ds_read_b128 v[88:91], v4 offset:13312
  ds_read_b128 v[92:95], v4 offset:17408
  s_waitcnt vmcnt(16) lgkmcnt(2)
  v_mfma_f32_32x32x16_bf16 v[16:31], v[80:83], v[144:147], v[16:31]
  v_mfma_f32_32x32x16_bf16 v[32:47], v[84:87], v[144:147], v[32:47]
  buffer_load_dwordx4 v[212:215], v1, s[12:15], s28 offen offset:1024 sc1
  ds_read_b128 v[80:83], v4 offset:14336
  ds_read_b128 v[84:87], v4 offset:18432
  s_waitcnt vmcnt(16) lgkmcnt(2)
  v_mfma_f32_32x32x16_bf16 v[16:31], v[88:91], v[148:151], v[16:31]
  v_mfma_f32_32x32x16_bf16 v[32:47], v[92:95], v[148:151], v[32:47]
  buffer_load_dwordx4 v[216:219], v1, s[12:15], s28 offen offset:2048 sc1
  ds_read_b128 v[88:91], v4 offset:15360
  ds_read_b128 v[92:95], v4 offset:19456
  s_waitcnt vmcnt(16) lgkmcnt(2)
  v_mfma_f32_32x32x16_bf16 v[16:31], v[80:83], v[152:155], v[16:31]
  v_mfma_f32_32x32x16_bf16 v[32:47], v[84:87], v[152:155], v[32:47]
  buffer_load_dwordx4 v[220:223], v1, s[12:15], s28 offen offset:3072 sc1
  ds_read_b128 v[80:83], v4 offset:20480
  ds_read_b128 v[84:87], v4 offset:24576
  s_waitcnt vmcnt(16) lgkmcnt(2)
  v_mfma_f32_32x32x16_bf16 v[16:31], v[88:91], v[156:159], v[16:31]
  v_mfma_f32_32x32x16_bf16 v[32:47], v[92:95], v[156:159], v[32:47]
  s_add_u32 s28, s90, 24576
  buffer_load_dwordx4 v[224:227], v1, s[12:15], s28 offen offset:0 sc1
  ds_read_b128 v[88:91], v4 offset:21504
  ds_read_b128 v[92:95], v4 offset:25600
  s_waitcnt vmcnt(16) lgkmcnt(2)
  v_mfma_f32_32x32x16_bf16 v[16:31], v[80:83], v[160:163], v[16:31]
  v_mfma_f32_32x32x16_bf16 v[32:47], v[84:87], v[160:163], v[32:47]
  buffer_load_dwordx4 v[228:231], v1, s[12:15], s28 offen offset:1024 sc1
  ds_read_b128 v[80:83], v4 offset:22528
  ds_read_b128 v[84:87], v4 offset:26624
  s_waitcnt vmcnt(16) lgkmcnt(2)
  v_mfma_f32_32x32x16_bf16 v[16:31], v[88:91], v[164:167], v[16:31]
  v_mfma_f32_32x32x16_bf16 v[32:47], v[92:95], v[164:167], v[32:47]
  buffer_load_dwordx4 v[232:235], v1, s[12:15], s28 offen offset:2048 sc1
  ds_read_b128 v[88:91], v4 offset:23552
  ds_read_b128 v[92:95], v4 offset:27648
  s_waitcnt vmcnt(16) lgkmcnt(2)
  v_mfma_f32_32x32x16_bf16 v[16:31], v[80:83], v[168:171], v[16:31]
  v_mfma_f32_32x32x16_bf16 v[32:47], v[84:87], v[168:171], v[32:47]
  buffer_load_dwordx4 v[236:239], v1, s[12:15], s28 offen offset:3072 sc1
  ds_read_b128 v[80:83], v4 offset:28672
  ds_read_b128 v[84:87], v4 offset:32768
  s_waitcnt vmcnt(16) lgkmcnt(2)
  v_mfma_f32_32x32x16_bf16 v[16:31], v[88:91], v[172:175], v[16:31]
  v_mfma_f32_32x32x16_bf16 v[32:47], v[92:95], v[172:175], v[32:47]
  s_add_u32 s28, s90, 28672
  buffer_load_dwordx4 v[240:243], v1, s[12:15], s28 offen offset:0 sc1
  ds_read_b128 v[88:91], v4 offset:29696
  ds_read_b128 v[92:95], v4 offset:33792
  s_waitcnt vmcnt(16) lgkmcnt(2)
  v_mfma_f32_32x32x16_bf16 v[16:31], v[80:83], v[176:179], v[16:31]
  v_mfma_f32_32x32x16_bf16 v[32:47], v[84:87], v[176:179], v[32:47]
  buffer_load_dwordx4 v[244:247], v1, s[12:15], s28 offen offset:1024 sc1
  ds_read_b128 v[80:83], v4 offset:30720
  ds_read_b128 v[84:87], v4 offset:34816
  s_waitcnt vmcnt(16) lgkmcnt(2)
  v_mfma_f32_32x32x16_bf16 v[16:31], v[88:91], v[180:183], v[16:31]
  v_mfma_f32_32x32x16_bf16 v[32:47], v[92:95], v[180:183], v[32:47]
  buffer_load_dwordx4 v[248:251], v1, s[12:15], s28 offen offset:2048 sc1
  ds_read_b128 v[88:91], v4 offset:31744
  ds_read_b128 v[92:95], v4 offset:35840
  s_waitcnt vmcnt(16) lgkmcnt(2)
  v_mfma_f32_32x32x16_bf16 v[16:31], v[80:83], v[184:187], v[16:31]
  v_mfma_f32_32x32x16_bf16 v[32:47], v[84:87], v[184:187], v[32:47]
  buffer_load_dwordx4 v[252:255], v1, s[12:15], s28 offen offset:3072 sc1
  ds_read_b128 v[80:83], v4 offset:53248
  ds_read_b128 v[84:87], v4 offset:57344
  s_waitcnt vmcnt(16) lgkmcnt(2)
  v_mfma_f32_32x32x16_bf16 v[16:31], v[88:91], v[188:191], v[16:31]
  v_mfma_f32_32x32x16_bf16 v[32:47], v[92:95], v[188:191], v[32:47]
  ds_read_b128 v[88:91], v4 offset:54272
  ds_read_b128 v[92:95], v4 offset:58368
  s_waitcnt vmcnt(15) lgkmcnt(2)
  v_mfma_f32_32x32x16_bf16 v[16:31], v[80:83], v[192:195], v[16:31]
  v_mfma_f32_32x32x16_bf16 v[32:47], v[84:87], v[192:195], v[32:47]
  ds_read_b128 v[80:83], v4 offset:55296
  ds_read_b128 v[84:87], v4 offset:59392
  s_waitcnt vmcnt(14) lgkmcnt(2)
  v_mfma_f32_32x32x16_bf16 v[16:31], v[88:91], v[196:199], v[16:31]
  v_mfma_f32_32x32x16_bf16 v[32:47], v[92:95], v[196:199], v[32:47]
  ds_read_b128 v[88:91], v4 offset:56320
  ds_read_b128 v[92:95], v4 offset:60416
  s_waitcnt vmcnt(13) lgkmcnt(2)
  v_mfma_f32_32x32x16_bf16 v[16:31], v[80:83], v[200:203], v[16:31]
  v_mfma_f32_32x32x16_bf16 v[32:47], v[84:87], v[200:203], v[32:47]
  ds_read_b128 v[80:83], v5 offset:0
  ds_read_b128 v[84:87], v5 offset:4096
  s_waitcnt vmcnt(12) lgkmcnt(2)
  v_mfma_f32_32x32x16_bf16 v[16:31], v[88:91], v[204:207], v[16:31]
  v_mfma_f32_32x32x16_bf16 v[32:47], v[92:95], v[204:207], v[32:47]
  ds_read_b128 v[88:91], v5 offset:1024
  ds_read_b128 v[92:95], v5 offset:5120
  s_waitcnt vmcnt(11) lgkmcnt(2)
  v_mfma_f32_32x32x16_bf16 v[16:31], v[80:83], v[208:211], v[16:31]
  v_mfma_f32_32x32x16_bf16 v[32:47], v[84:87], v[208:211], v[32:47]
  ds_read_b128 v[80:83], v5 offset:2048
  ds_read_b128 v[84:87], v5 offset:6144
  s_waitcnt vmcnt(10) lgkmcnt(2)
  v_mfma_f32_32x32x16_bf16 v[16:31], v[88:91], v[212:215], v[16:31]
  v_mfma_f32_32x32x16_bf16 v[32:47], v[92:95], v[212:215], v[32:47]
  ds_read_b128 v[88:91], v5 offset:3072
  ds_read_b128 v[92:95], v5 offset:7168
  s_waitcnt vmcnt(9) lgkmcnt(2)
  v_mfma_f32_32x32x16_bf16 v[16:31], v[80:83], v[216:219], v[16:31]
  v_mfma_f32_32x32x16_bf16 v[32:47], v[84:87], v[216:219], v[32:47]
  ds_read_b128 v[80:83], v5 offset:8192
  ds_read_b128 v[84:87], v5 offset:12288
  s_waitcnt vmcnt(8) lgkmcnt(2)
  v_mfma_f32_32x32x16_bf16 v[16:31], v[88:91], v[220:223], v[16:31]
  v_mfma_f32_32x32x16_bf16 v[32:47], v[92:95], v[220:223], v[32:47]
  ds_read_b128 v[88:91], v5 offset:9216
  ds_read_b128 v[92:95], v5 offset:13312
  s_waitcnt vmcnt(7) lgkmcnt(2)
  v_mfma_f32_32x32x16_bf16 v[16:31], v[80:83], v[224:227], v[16:31]
  v_mfma_f32_32x32x16_bf16 v[32:47], v[84:87], v[224:227], v[32:47]
  ds_read_b128 v[80:83], v5 offset:10240
  ds_read_b128 v[84:87], v5 offset:14336
  s_waitcnt vmcnt(6) lgkmcnt(2)
  v_mfma_f32_32x32x16_bf16 v[16:31], v[88:91], v[228:231], v[16:31]
  v_mfma_f32_32x32x16_bf16 v[32:47], v[92:95], v[228:231], v[32:47]
  ds_read_b128 v[88:91], v5 offset:11264
  ds_read_b128 v[92:95], v5 offset:15360
  s_waitcnt vmcnt(5) lgkmcnt(2)
  v_mfma_f32_32x32x16_bf16 v[16:31], v[80:83], v[232:235], v[16:31]
  v_mfma_f32_32x32x16_bf16 v[32:47], v[84:87], v[232:235], v[32:47]
  ds_read_b128 v[80:83], v5 offset:16384
  ds_read_b128 v[84:87], v5 offset:20480
  s_waitcnt vmcnt(4) lgkmcnt(2)
  v_mfma_f32_32x32x16_bf16 v[16:31], v[88:91], v[236:239], v[16:31]
  v_mfma_f32_32x32x16_bf16 v[32:47], v[92:95], v[236:239], v[32:47]
  ds_read_b128 v[88:91], v5 offset:17408
  ds_read_b128 v[92:95], v5 offset:21504
  s_waitcnt vmcnt(3) lgkmcnt(2)
  v_mfma_f32_32x32x16_bf16 v[16:31], v[80:83], v[240:243], v[16:31]
  v_mfma_f32_32x32x16_bf16 v[32:47], v[84:87], v[240:243], v[32:47]
  ds_read_b128 v[80:83], v5 offset:18432
  ds_read_b128 v[84:87], v5 offset:22528
  s_waitcnt vmcnt(2) lgkmcnt(2)
  v_mfma_f32_32x32x16_bf16 v[16:31], v[88:91], v[244:247], v[16:31]
  v_mfma_f32_32x32x16_bf16 v[32:47], v[92:95], v[244:247], v[32:47]
  ds_read_b128 v[88:91], v5 offset:19456
  ds_read_b128 v[92:95], v5 offset:23552
  s_waitcnt vmcnt(1) lgkmcnt(2)
  v_mfma_f32_32x32x16_bf16 v[16:31], v[80:83], v[248:251], v[16:31]
  v_mfma_f32_32x32x16_bf16 v[32:47], v[84:87], v[248:251], v[32:47]
  s_barrier
  ds_read_b128 v[80:83], v5 offset:24576
  ds_read_b128 v[84:87], v5 offset:28672
  s_waitcnt vmcnt(0) lgkmcnt(2)
  v_mfma_f32_32x32x16_bf16 v[16:31], v[88:91], v[252:255], v[16:31]
  v_mfma_f32_32x32x16_bf16 v[32:47], v[92:95], v[252:255], v[32:47]
  v_mfma_f32_32x32x16_bf16 v[48:63], v[104:107], v[12:15], 0
  v_mfma_f32_32x32x16_bf16 v[64:79], v[108:111], v[12:15], 0
  ds_read_b128 v[88:91], v5 offset:25600
  ds_read_b128 v[92:95], v5 offset:29696
  s_waitcnt lgkmcnt(2)
  v_mfma_f32_32x32x16_bf16 v[48:63], v[80:83], v[128:131], v[48:63]
  v_mfma_f32_32x32x16_bf16 v[64:79], v[84:87], v[128:131], v[64:79]
  ds_read_b128 v[80:83], v5 offset:26624
  ds_read_b128 v[84:87], v5 offset:30720
  s_waitcnt lgkmcnt(2)
  v_mfma_f32_32x32x16_bf16 v[48:63], v[88:91], v[132:135], v[48:63]
  v_mul_f32 v120, v16, v9
  v_mul_f32 v121, v17, v9
  v_mul_f32 v122, v18, v9
  v_mul_f32 v123, v19, v9
  v_mfma_f32_32x32x16_bf16 v[64:79], v[92:95], v[132:135], v[64:79]
  v_mul_f32 v124, v20, v9
  v_mul_f32 v125, v21, v9
  v_mul_f32 v126, v22, v9
  ds_read_b128 v[88:91], v5 offset:27648
  ds_read_b128 v[92:95], v5 offset:31744
  s_waitcnt lgkmcnt(2)
  v_mfma_f32_32x32x16_bf16 v[48:63], v[80:83], v[136:139], v[48:63]
  v_mul_f32 v127, v23, v9
  v_exp_f32 v120, v120
  v_mul_f32 v16, v16, v24
  v_mfma_f32_32x32x16_bf16 v[64:79], v[84:87], v[136:139], v[64:79]
  v_exp_f32 v121, v121
  v_mul_f32 v17, v17, v25
  ds_read_b128 v[80:83], v5 offset:32768
  ds_read_b128 v[84:87], v5 offset:36864
  s_waitcnt lgkmcnt(2)
  v_mfma_f32_32x32x16_bf16 v[48:63], v[88:91], v[140:143], v[48:63]
  v_exp_f32 v122, v122
  v_mul_f32 v18, v18, v26
  v_exp_f32 v123, v123
  v_mfma_f32_32x32x16_bf16 v[64:79], v[92:95], v[140:143], v[64:79]
  v_mul_f32 v19, v19, v27
  v_exp_f32 v124, v124
  ds_read_b128 v[88:91], v5 offset:33792
  ds_read_b128 v[92:95], v5 offset:37888
  s_waitcnt lgkmcnt(2)
  v_mfma_f32_32x32x16_bf16 v[48:63], v[80:83], v[144:147], v[48:63]
  v_mul_f32 v20, v20, v28
  v_exp_f32 v125, v125
  v_mfma_f32_32x32x16_bf16 v[64:79], v[84:87], v[144:147], v[64:79]
  v_mul_f32 v21, v21, v29
  v_exp_f32 v126, v126
  ds_read_b128 v[80:83], v5 offset:34816
  ds_read_b128 v[84:87], v5 offset:38912
  s_waitcnt lgkmcnt(2)
  v_mfma_f32_32x32x16_bf16 v[48:63], v[88:91], v[148:151], v[48:63]
  v_mul_f32 v22, v22, v30
  v_exp_f32 v127, v127
  v_mul_f32 v23, v23, v31
  v_mfma_f32_32x32x16_bf16 v[64:79], v[92:95], v[148:151], v[64:79]
  v_fma_f32 v120, v120, v10, v10
  v_fma_f32 v121, v121, v10, v10
  v_fma_f32 v122, v122, v10, v10
  ds_read_b128 v[88:91], v5 offset:35840
  ds_read_b128 v[92:95], v5 offset:39936
  s_waitcnt lgkmcnt(2)
  v_mfma_f32_32x32x16_bf16 v[48:63], v[80:83], v[152:155], v[48:63]
  v_fma_f32 v123, v123, v10, v10
  v_fma_f32 v124, v124, v10, v10
  v_fma_f32 v125, v125, v10, v10
  v_fma_f32 v126, v126, v10, v10
  v_mfma_f32_32x32x16_bf16 v[64:79], v[84:87], v[152:155], v[64:79]
  v_fma_f32 v127, v127, v10, v10
  v_rcp_f32 v120, v120
  ds_read_b128 v[80:83], v1 offset:0
  ds_read_b128 v[84:87], v1 offset:4096
  s_waitcnt lgkmcnt(2)
  v_mfma_f32_32x32x16_bf16 v[48:63], v[88:91], v[156:159], v[48:63]
  v_rcp_f32 v121, v121
  v_rcp_f32 v122, v122
  v_mfma_f32_32x32x16_bf16 v[64:79], v[92:95], v[156:159], v[64:79]
  v_rcp_f32 v123, v123
  v_rcp_f32 v124, v124
  ds_read_b128 v[88:91], v1 offset:1024
  ds_read_b128 v[92:95], v1 offset:5120
  s_waitcnt lgkmcnt(2)
  v_mfma_f32_32x32x16_bf16 v[48:63], v[80:83], v[160:163], v[48:63]
  v_rcp_f32 v125, v125
  v_rcp_f32 v126, v126
  v_mfma_f32_32x32x16_bf16 v[64:79], v[84:87], v[160:163], v[64:79]
  v_rcp_f32 v127, v127
  ds_read_b128 v[80:83], v1 offset:2048
  ds_read_b128 v[84:87], v1 offset:6144
  s_waitcnt lgkmcnt(2)
  v_mfma_f32_32x32x16_bf16 v[48:63], v[88:91], v[164:167], v[48:63]
  s_nop 0
  v_mul_f32 v16, v16, v120
  v_mul_f32 v17, v17, v121
  v_mul_f32 v18, v18, v122
  v_mfma_f32_32x32x16_bf16 v[64:79], v[92:95], v[164:167], v[64:79]
  v_mul_f32 v19, v19, v123
  v_mul_f32 v20, v20, v124
  v_mul_f32 v21, v21, v125
  ds_read_b128 v[88:91], v1 offset:3072
  ds_read_b128 v[92:95], v1 offset:7168
  s_waitcnt lgkmcnt(2)
  v_mfma_f32_32x32x16_bf16 v[48:63], v[80:83], v[168:171], v[48:63]
  v_mul_f32 v22, v22, v126
  v_mul_f32 v23, v23, v127
  v_cvt_pk_bf16_f32 v24, v16, v17
  v_cvt_pk_bf16_f32 v25, v18, v19
  v_mfma_f32_32x32x16_bf16 v[64:79], v[84:87], v[168:171], v[64:79]
  v_cvt_pk_bf16_f32 v26, v20, v21
  v_cvt_pk_bf16_f32 v27, v22, v23
  s_add_u32 s28, s21, 0
  s_add_u32 s29, s91, 0
  s_cmp_ge_u32 s28, 86
  s_cselect_b32 s29, 0x40000000, s29
  s_cmp_eq_u32 s101, 1
  s_cbranch_scc1 L_interleave_layers__sliding_block__glu_gated_swiglu__prompt_25
  buffer_store_dwordx4 v[24:27], v1, s[12:15], s29 offen sc1
  s_branch L_interleave_layers__sliding_block__glu_gated_swiglu__prompt_26
L_interleave_layers__sliding_block__glu_gated_swiglu__prompt_25:
  buffer_store_dwordx4 v[24:27], v1, s[12:15], s29 offen
L_interleave_layers__sliding_block__glu_gated_swiglu__prompt_26:
  ds_read_b128 v[80:83], v1 offset:8192
  ds_read_b128 v[84:87], v1 offset:12288
  s_waitcnt lgkmcnt(2)
  v_mfma_f32_32x32x16_bf16 v[48:63], v[88:91], v[172:175], v[48:63]
  v_mul_f32 v120, v32, v9
  v_mfma_f32_32x32x16_bf16 v[64:79], v[92:95], v[172:175], v[64:79]
  v_mul_f32 v121, v33, v9
  v_mul_f32 v122, v34, v9
  v_mul_f32 v123, v35, v9
  ds_read_b128 v[88:91], v1 offset:9216
  ds_read_b128 v[92:95], v1 offset:13312
  s_waitcnt lgkmcnt(2)
  v_mfma_f32_32x32x16_bf16 v[48:63], v[80:83], v[176:179], v[48:63]
  v_mul_f32 v124, v36, v9
  v_mul_f32 v125, v37, v9
  v_mul_f32 v126, v38, v9
  v_mul_f32 v127, v39, v9
  v_mfma_f32_32x32x16_bf16 v[64:79], v[84:87], v[176:179], v[64:79]
  v_exp_f32 v120, v120
  v_mul_f32 v32, v32, v40
  ds_read_b128 v[80:83], v1 offset:10240
  ds_read_b128 v[84:87], v1 offset:14336
  s_waitcnt lgkmcnt(2)
  v_mfma_f32_32x32x16_bf16 v[48:63], v[88:91], v[180:183], v[48:63]
  v_exp_f32 v121, v121
  v_mul_f32 v33, v33, v41
  v_exp_f32 v122, v122
  v_mfma_f32_32x32x16_bf16 v[64:79], v[92:95], v[180:183], v[64:79]
  v_mul_f32 v34, v34, v42
  v_exp_f32 v123, v123
  ds_read_b128 v[88:91], v1 offset:11264
  ds_read_b128 v[92:95], v1 offset:15360
  s_waitcnt lgkmcnt(2)
  v_mfma_f32_32x32x16_bf16 v[48:63], v[80:83], v[184:187], v[48:63]
  v_mul_f32 v35, v35, v43
  v_exp_f32 v124, v124
  v_mfma_f32_32x32x16_bf16 v[64:79], v[84:87], v[184:187], v[64:79]
  v_mul_f32 v36, v36, v44
  v_exp_f32 v125, v125
  ds_read_b128 v[80:83], v1 offset:16384
  ds_read_b128 v[84:87], v1 offset:20480
  s_waitcnt lgkmcnt(2)
  v_mfma_f32_32x32x16_bf16 v[48:63], v[88:91], v[188:191], v[48:63]
  v_mul_f32 v37, v37, v45
  v_exp_f32 v126, v126
  v_mul_f32 v38, v38, v46
  v_mfma_f32_32x32x16_bf16 v[64:79], v[92:95], v[188:191], v[64:79]
  v_exp_f32 v127, v127
  v_mul_f32 v39, v39, v47
  ds_read_b128 v[88:91], v1 offset:17408
  ds_read_b128 v[92:95], v1 offset:21504
  s_waitcnt lgkmcnt(2)
  v_mfma_f32_32x32x16_bf16 v[48:63], v[80:83], v[192:195], v[48:63]
  v_fma_f32 v120, v120, v10, v10
  v_fma_f32 v121, v121, v10, v10
  v_fma_f32 v122, v122, v10, v10
  v_fma_f32 v123, v123, v10, v10
  v_mfma_f32_32x32x16_bf16 v[64:79], v[84:87], v[192:195], v[64:79]
  v_fma_f32 v124, v124, v10, v10
  v_fma_f32 v125, v125, v10, v10
  v_fma_f32 v126, v126, v10, v10
  ds_read_b128 v[80:83], v1 offset:18432
  ds_read_b128 v[84:87], v1 offset:22528
  s_waitcnt lgkmcnt(2)
  v_mfma_f32_32x32x16_bf16 v[48:63], v[88:91], v[196:199], v[48:63]
  v_fma_f32 v127, v127, v10, v10
  v_rcp_f32 v120, v120
  v_rcp_f32 v121, v121
  v_mfma_f32_32x32x16_bf16 v[64:79], v[92:95], v[196:199], v[64:79]
  v_rcp_f32 v122, v122
  ds_read_b128 v[88:91], v1 offset:19456
  ds_read_b128 v[92:95], v1 offset:23552
  s_waitcnt lgkmcnt(2)
  v_mfma_f32_32x32x16_bf16 v[48:63], v[80:83], v[200:203], v[48:63]
  v_rcp_f32 v123, v123
  v_rcp_f32 v124, v124
  v_mfma_f32_32x32x16_bf16 v[64:79], v[84:87], v[200:203], v[64:79]
  v_rcp_f32 v125, v125
  v_rcp_f32 v126, v126
  ds_read_b128 v[80:83], v1 offset:24576
  ds_read_b128 v[84:87], v1 offset:28672
  s_waitcnt lgkmcnt(2)
  v_mfma_f32_32x32x16_bf16 v[48:63], v[88:91], v[204:207], v[48:63]
  v_rcp_f32 v127, v127
  s_nop 0
  v_mfma_f32_32x32x16_bf16 v[64:79], v[92:95], v[204:207], v[64:79]
  v_mul_f32 v32, v32, v120
  v_mul_f32 v33, v33, v121
  v_mul_f32 v34, v34, v122
  ds_read_b128 v[88:91], v1 offset:25600
  ds_read_b128 v[92:95], v1 offset:29696
  s_waitcnt lgkmcnt(2)
  v_mfma_f32_32x32x16_bf16 v[48:63], v[80:83], v[208:211], v[48:63]
  v_mul_f32 v35, v35, v123
  v_mul_f32 v36, v36, v124
  v_mul_f32 v37, v37, v125
  v_mul_f32 v38, v38, v126
  v_mfma_f32_32x32x16_bf16 v[64:79], v[84:87], v[208:211], v[64:79]
  v_mul_f32 v39, v39, v127
  v_cvt_pk_bf16_f32 v40, v32, v33
  v_cvt_pk_bf16_f32 v41, v34, v35
  ds_read_b128 v[80:83], v1 offset:26624
  ds_read_b128 v[84:87], v1 offset:30720
  s_waitcnt lgkmcnt(2)
  v_mfma_f32_32x32x16_bf16 v[48:63], v[88:91], v[212:215], v[48:63]
  v_cvt_pk_bf16_f32 v42, v36, v37
  v_cvt_pk_bf16_f32 v43, v38, v39
  s_add_u32 s28, s21, 1
  s_add_u32 s29, s91, 1024
  s_cmp_ge_u32 s28, 86
  s_cselect_b32 s29, 0x40000000, s29
  s_cmp_eq_u32 s101, 1
  s_cbranch_scc1 L_interleave_layers__sliding_block__glu_gated_swiglu__prompt_27
  buffer_store_dwordx4 v[40:43], v1, s[12:15], s29 offen sc1
  s_branch L_interleave_layers__sliding_block__glu_gated_swiglu__prompt_28
L_interleave_layers__sliding_block__glu_gated_swiglu__prompt_27:
  buffer_store_dwordx4 v[40:43], v1, s[12:15], s29 offen
L_interleave_layers__sliding_block__glu_gated_swiglu__prompt_28:
  v_mfma_f32_32x32x16_bf16 v[64:79], v[92:95], v[212:215], v[64:79]
  ds_read_b128 v[88:91], v1 offset:27648
  ds_read_b128 v[92:95], v1 offset:31744
  s_waitcnt lgkmcnt(2)
  v_mfma_f32_32x32x16_bf16 v[48:63], v[80:83], v[216:219], v[48:63]
  v_mfma_f32_32x32x16_bf16 v[64:79], v[84:87], v[216:219], v[64:79]
  ds_read_b128 v[80:83], v1 offset:32768
  ds_read_b128 v[84:87], v1 offset:36864
  s_waitcnt lgkmcnt(2)
  v_mfma_f32_32x32x16_bf16 v[48:63], v[88:91], v[220:223], v[48:63]
  v_mfma_f32_32x32x16_bf16 v[64:79], v[92:95], v[220:223], v[64:79]
  ds_read_b128 v[88:91], v1 offset:33792
  ds_read_b128 v[92:95], v1 offset:37888
  s_waitcnt lgkmcnt(2)
  v_mfma_f32_32x32x16_bf16 v[48:63], v[80:83], v[224:227], v[48:63]
  v_mfma_f32_32x32x16_bf16 v[64:79], v[84:87], v[224:227], v[64:79]
  ds_read_b128 v[80:83], v1 offset:34816
  ds_read_b128 v[84:87], v1 offset:38912
  s_waitcnt lgkmcnt(2)
  v_mfma_f32_32x32x16_bf16 v[48:63], v[88:91], v[228:231], v[48:63]
  v_mfma_f32_32x32x16_bf16 v[64:79], v[92:95], v[228:231], v[64:79]
  ds_read_b128 v[88:91], v1 offset:35840
  ds_read_b128 v[92:95], v1 offset:39936
  s_waitcnt lgkmcnt(2)
  v_mfma_f32_32x32x16_bf16 v[48:63], v[80:83], v[232:235], v[48:63]
  v_mfma_f32_32x32x16_bf16 v[64:79], v[84:87], v[232:235], v[64:79]
  ds_read_b128 v[80:83], v1 offset:40960
  ds_read_b128 v[84:87], v1 offset:45056
  s_waitcnt lgkmcnt(2)
  v_mfma_f32_32x32x16_bf16 v[48:63], v[88:91], v[236:239], v[48:63]
  v_mfma_f32_32x32x16_bf16 v[64:79], v[92:95], v[236:239], v[64:79]
  ds_read_b128 v[88:91], v1 offset:41984
  ds_read_b128 v[92:95], v1 offset:46080
  s_waitcnt lgkmcnt(2)
  v_mfma_f32_32x32x16_bf16 v[48:63], v[80:83], v[240:243], v[48:63]
  v_mfma_f32_32x32x16_bf16 v[64:79], v[84:87], v[240:243], v[64:79]
  ds_read_b128 v[80:83], v1 offset:43008
  ds_read_b128 v[84:87], v1 offset:47104
  s_waitcnt lgkmcnt(2)
  v_mfma_f32_32x32x16_bf16 v[48:63], v[88:91], v[244:247], v[48:63]
  v_mfma_f32_32x32x16_bf16 v[64:79], v[92:95], v[244:247], v[64:79]
  ds_read_b128 v[88:91], v1 offset:44032
  ds_read_b128 v[92:95], v1 offset:48128
  s_waitcnt lgkmcnt(2)
  v_mfma_f32_32x32x16_bf16 v[48:63], v[80:83], v[248:251], v[48:63]
  v_mfma_f32_32x32x16_bf16 v[64:79], v[84:87], v[248:251], v[64:79]
  s_barrier
  ds_read_b128 v[80:83], v1 offset:49152
  ds_read_b128 v[84:87], v1 offset:53248
  s_waitcnt lgkmcnt(2)
  v_mfma_f32_32x32x16_bf16 v[48:63], v[88:91], v[252:255], v[48:63]
  v_mfma_f32_32x32x16_bf16 v[64:79], v[92:95], v[252:255], v[64:79]
  s_lshl_b32 s28, s19, 13
  s_lshl_b32 s29, s17, 2
  s_add_u32 s28, s28, s29
  s_add_u32 s28, s28, 0x1100000
  v_mov_b32 v7, s98
  v_mov_b32 v8, 0
  s_waitcnt vmcnt(0)
  s_mov_b64 exec, 1
  s_cmp_eq_u32 s101, 1
  s_cbranch_scc1 L_interleave_layers__sliding_block__glu_gated_swiglu__prompt_29
  buffer_store_dword v7, v8, s[12:15], s28 offen sc1
  s_branch L_interleave_layers__sliding_block__glu_gated_swiglu__prompt_30
L_interleave_layers__sliding_block__glu_gated_swiglu__prompt_29:
  buffer_store_dword v7, v8, s[12:15], s28 offen
L_interleave_layers__sliding_block__glu_gated_swiglu__prompt_30:
  s_mov_b64 exec, -1
  v_mfma_f32_32x32x16_bf16 v[16:31], v[112:115], v[12:15], 0
  v_mfma_f32_32x32x16_bf16 v[32:47], v[116:119], v[12:15], 0
  ds_read_b128 v[88:91], v1 offset:50176
  ds_read_b128 v[92:95], v1 offset:54272
  s_waitcnt lgkmcnt(2)
  v_mfma_f32_32x32x16_bf16 v[16:31], v[80:83], v[128:131], v[16:31]
  v_mfma_f32_32x32x16_bf16 v[32:47], v[84:87], v[128:131], v[32:47]
  ds_read_b128 v[80:83], v1 offset:51200
  ds_read_b128 v[84:87], v1 offset:55296
  s_waitcnt lgkmcnt(2)
  v_mfma_f32_32x32x16_bf16 v[16:31], v[88:91], v[132:135], v[16:31]
  v_mul_f32 v120, v48, v9
  v_mul_f32 v121, v49, v9
  v_mul_f32 v122, v50, v9
  v_mul_f32 v123, v51, v9
  v_mfma_f32_32x32x16_bf16 v[32:47], v[92:95], v[132:135], v[32:47]
  v_mul_f32 v124, v52, v9
  v_mul_f32 v125, v53, v9
  v_mul_f32 v126, v54, v9
  ds_read_b128 v[88:91], v1 offset:52224
  ds_read_b128 v[92:95], v1 offset:56320
  s_waitcnt lgkmcnt(2)
  v_mfma_f32_32x32x16_bf16 v[16:31], v[80:83], v[136:139], v[16:31]
  v_mul_f32 v127, v55, v9
  v_exp_f32 v120, v120
  v_mul_f32 v48, v48, v56
  v_mfma_f32_32x32x16_bf16 v[32:47], v[84:87], v[136:139], v[32:47]
  v_exp_f32 v121, v121
  v_mul_f32 v49, v49, v57
  ds_read_b128 v[80:83], v1 offset:57344
  ds_read_b128 v[84:87], v4 offset:0
  s_waitcnt lgkmcnt(2)
  v_mfma_f32_32x32x16_bf16 v[16:31], v[88:91], v[140:143], v[16:31]
  v_exp_f32 v122, v122
  v_mul_f32 v50, v50, v58
  v_exp_f32 v123, v123
  v_mfma_f32_32x32x16_bf16 v[32:47], v[92:95], v[140:143], v[32:47]
  v_mul_f32 v51, v51, v59
  v_exp_f32 v124, v124
  ds_read_b128 v[88:91], v1 offset:58368
  ds_read_b128 v[92:95], v4 offset:1024
  s_waitcnt lgkmcnt(2)
  v_mfma_f32_32x32x16_bf16 v[16:31], v[80:83], v[144:147], v[16:31]
  v_mul_f32 v52, v52, v60
  v_exp_f32 v125, v125
  v_mfma_f32_32x32x16_bf16 v[32:47], v[84:87], v[144:147], v[32:47]
  v_mul_f32 v53, v53, v61
  v_exp_f32 v126, v126
  ds_read_b128 v[80:83], v1 offset:59392
  ds_read_b128 v[84:87], v4 offset:2048
  s_waitcnt lgkmcnt(2)
  v_mfma_f32_32x32x16_bf16 v[16:31], v[88:91], v[148:151], v[16:31]
  v_mul_f32 v54, v54, v62
  v_exp_f32 v127, v127
  v_mul_f32 v55, v55, v63
  v_mfma_f32_32x32x16_bf16 v[32:47], v[92:95], v[148:151], v[32:47]
  v_fma_f32 v120, v120, v10, v10
  v_fma_f32 v121, v121, v10, v10
  v_fma_f32 v122, v122, v10, v10
  ds_read_b128 v[88:91], v1 offset:60416
  ds_read_b128 v[92:95], v4 offset:3072
  s_waitcnt lgkmcnt(2)
  v_mfma_f32_32x32x16_bf16 v[16:31], v[80:83], v[152:155], v[16:31]
  v_fma_f32 v123, v123, v10, v10
  v_fma_f32 v124, v124, v10, v10
  v_fma_f32 v125, v125, v10, v10
  v_fma_f32 v126, v126, v10, v10
  v_mfma_f32_32x32x16_bf16 v[32:47], v[84:87], v[152:155], v[32:47]
  v_fma_f32 v127, v127, v10, v10
  v_rcp_f32 v120, v120
  ds_read_b128 v[80:83], v4 offset:4096
  ds_read_b128 v[84:87], v4 offset:8192
  s_waitcnt lgkmcnt(2)
  v_mfma_f32_32x32x16_bf16 v[16:31], v[88:91], v[156:159], v[16:31]
  v_rcp_f32 v121, v121
  v_rcp_f32 v122, v122
  v_mfma_f32_32x32x16_bf16 v[32:47], v[92:95], v[156:159], v[32:47]
  v_rcp_f32 v123, v123
  v_rcp_f32 v124, v124
  ds_read_b128 v[88:91], v4 offset:5120
  ds_read_b128 v[92:95], v4 offset:9216
  s_waitcnt lgkmcnt(2)
  v_mfma_f32_32x32x16_bf16 v[16:31], v[80:83], v[160:163], v[16:31]
  v_rcp_f32 v125, v125
  v_rcp_f32 v126, v126
  v_mfma_f32_32x32x16_bf16 v[32:47], v[84:87], v[160:163], v[32:47]
  v_rcp_f32 v127, v127
  ds_read_b128 v[80:83], v4 offset:6144
  ds_read_b128 v[84:87], v4 offset:10240
  s_waitcnt lgkmcnt(2)
  v_mfma_f32_32x32x16_bf16 v[16:31], v[88:91], v[164:167], v[16:31]
  s_nop 0
  v_mul_f32 v48, v48, v120
  v_mul_f32 v49, v49, v121
  v_mul_f32 v50, v50, v122
  v_mfma_f32_32x32x16_bf16 v[32:47], v[92:95], v[164:167], v[32:47]
  v_mul_f32 v51, v51, v123
  v_mul_f32 v52, v52, v124
  v_mul_f32 v53, v53, v125
  ds_read_b128 v[88:91], v4 offset:7168
  ds_read_b128 v[92:95], v4 offset:11264
  s_waitcnt lgkmcnt(2)
  v_mfma_f32_32x32x16_bf16 v[16:31], v[80:83], v[168:171], v[16:31]
  v_mul_f32 v54, v54, v126
  v_mul_f32 v55, v55, v127
  v_cvt_pk_bf16_f32 v56, v48, v49
  v_cvt_pk_bf16_f32 v57, v50, v51
  v_mfma_f32_32x32x16_bf16 v[32:47], v[84:87], v[168:171], v[32:47]
  v_cvt_pk_bf16_f32 v58, v52, v53
  v_cvt_pk_bf16_f32 v59, v54, v55
  s_add_u32 s28, s21, 2
  s_add_u32 s29, s91, 32768
  s_cmp_ge_u32 s28, 86
  s_cselect_b32 s29, 0x40000000, s29
  s_cmp_eq_u32 s101, 1
  s_cbranch_scc1 L_interleave_layers__sliding_block__glu_gated_swiglu__prompt_31
  buffer_store_dwordx4 v[56:59], v1, s[12:15], s29 offen sc1
  s_branch L_interleave_layers__sliding_block__glu_gated_swiglu__prompt_32
L_interleave_layers__sliding_block__glu_gated_swiglu__prompt_31:
  buffer_store_dwordx4 v[56:59], v1, s[12:15], s29 offen
L_interleave_layers__sliding_block__glu_gated_swiglu__prompt_32:
  ds_read_b128 v[80:83], v4 offset:12288
  ds_read_b128 v[84:87], v4 offset:16384
  s_waitcnt lgkmcnt(2)
  v_mfma_f32_32x32x16_bf16 v[16:31], v[88:91], v[172:175], v[16:31]
  v_mul_f32 v120, v64, v9
  v_mfma_f32_32x32x16_bf16 v[32:47], v[92:95], v[172:175], v[32:47]
  v_mul_f32 v121, v65, v9
  v_mul_f32 v122, v66, v9
  v_mul_f32 v123, v67, v9
  ds_read_b128 v[88:91], v4 offset:13312
  ds_read_b128 v[92:95], v4 offset:17408
  s_waitcnt lgkmcnt(2)
  v_mfma_f32_32x32x16_bf16 v[16:31], v[80:83], v[176:179], v[16:31]
  v_mul_f32 v124, v68, v9
  v_mul_f32 v125, v69, v9
  v_mul_f32 v126, v70, v9
  v_mul_f32 v127, v71, v9
  v_mfma_f32_32x32x16_bf16 v[32:47], v[84:87], v[176:179], v[32:47]
  v_exp_f32 v120, v120
  v_mul_f32 v64, v64, v72
  ds_read_b128 v[80:83], v4 offset:14336
  ds_read_b128 v[84:87], v4 offset:18432
  s_waitcnt lgkmcnt(2)
  v_mfma_f32_32x32x16_bf16 v[16:31], v[88:91], v[180:183], v[16:31]
  v_exp_f32 v121, v121
  v_mul_f32 v65, v65, v73
  v_exp_f32 v122, v122
  v_mfma_f32_32x32x16_bf16 v[32:47], v[92:95], v[180:183], v[32:47]
  v_mul_f32 v66, v66, v74
  v_exp_f32 v123, v123
  ds_read_b128 v[88:91], v4 offset:15360
  ds_read_b128 v[92:95], v4 offset:19456
  s_waitcnt lgkmcnt(2)
  v_mfma_f32_32x32x16_bf16 v[16:31], v[80:83], v[184:187], v[16:31]
  v_mul_f32 v67, v67, v75
  v_exp_f32 v124, v124
  v_mfma_f32_32x32x16_bf16 v[32:47], v[84:87], v[184:187], v[32:47]
  v_mul_f32 v68, v68, v76
  v_exp_f32 v125, v125
  s_barrier
  ds_read_b128 v[80:83], v4 offset:20480
  ds_read_b128 v[84:87], v4 offset:24576
  s_waitcnt lgkmcnt(2)
  v_mfma_f32_32x32x16_bf16 v[16:31], v[88:91], v[188:191], v[16:31]
  v_mul_f32 v69, v69, v77
  v_exp_f32 v126, v126
  v_mul_f32 v70, v70, v78
  v_mfma_f32_32x32x16_bf16 v[32:47], v[92:95], v[188:191], v[32:47]
  v_exp_f32 v127, v127
  v_mul_f32 v71, v71, v79
  ds_read_b128 v[88:91], v4 offset:21504
  ds_read_b128 v[92:95], v4 offset:25600
  s_waitcnt lgkmcnt(2)
  v_mfma_f32_32x32x16_bf16 v[16:31], v[80:83], v[192:195], v[16:31]
  v_fma_f32 v120, v120, v10, v10
  v_fma_f32 v121, v121, v10, v10
  v_fma_f32 v122, v122, v10, v10
  v_fma_f32 v123, v123, v10, v10
  v_mfma_f32_32x32x16_bf16 v[32:47], v[84:87], v[192:195], v[32:47]
  v_fma_f32 v124, v124, v10, v10
  v_fma_f32 v125, v125, v10, v10
  v_fma_f32 v126, v126, v10, v10
  ds_read_b128 v[80:83], v4 offset:22528
  ds_read_b128 v[84:87], v4 offset:26624
  s_waitcnt lgkmcnt(2)
  v_mfma_f32_32x32x16_bf16 v[16:31], v[88:91], v[196:199], v[16:31]
  v_fma_f32 v127, v127, v10, v10
  v_rcp_f32 v120, v120
  v_rcp_f32 v121, v121
  v_mfma_f32_32x32x16_bf16 v[32:47], v[92:95], v[196:199], v[32:47]
  v_rcp_f32 v122, v122
  ds_read_b128 v[88:91], v4 offset:23552
  ds_read_b128 v[92:95], v4 offset:27648
  s_waitcnt lgkmcnt(2)
  v_mfma_f32_32x32x16_bf16 v[16:31], v[80:83], v[200:203], v[16:31]
  v_rcp_f32 v123, v123
  v_rcp_f32 v124, v124
  v_mfma_f32_32x32x16_bf16 v[32:47], v[84:87], v[200:203], v[32:47]
  v_rcp_f32 v125, v125
  v_rcp_f32 v126, v126
  ds_read_b128 v[80:83], v4 offset:28672
  ds_read_b128 v[84:87], v4 offset:32768
  s_waitcnt lgkmcnt(2)
  v_mfma_f32_32x32x16_bf16 v[16:31], v[88:91], v[204:207], v[16:31]
  v_rcp_f32 v127, v127
  s_nop 0
  v_mfma_f32_32x32x16_bf16 v[32:47], v[92:95], v[204:207], v[32:47]
  v_mul_f32 v64, v64, v120
  v_mul_f32 v65, v65, v121
  v_mul_f32 v66, v66, v122
  ds_read_b128 v[88:91], v4 offset:29696
  ds_read_b128 v[92:95], v4 offset:33792
  s_waitcnt lgkmcnt(2)
  v_mfma_f32_32x32x16_bf16 v[16:31], v[80:83], v[208:211], v[16:31]
  v_mul_f32 v67, v67, v123
  v_mul_f32 v68, v68, v124
  v_mul_f32 v69, v69, v125
  v_mul_f32 v70, v70, v126
  v_mfma_f32_32x32x16_bf16 v[32:47], v[84:87], v[208:211], v[32:47]
  v_mul_f32 v71, v71, v127
  v_cvt_pk_bf16_f32 v72, v64, v65
  v_cvt_pk_bf16_f32 v73, v66, v67
  ds_read_b128 v[80:83], v4 offset:30720
  ds_read_b128 v[84:87], v4 offset:34816
  s_waitcnt lgkmcnt(2)
  v_mfma_f32_32x32x16_bf16 v[16:31], v[88:91], v[212:215], v[16:31]
  v_cvt_pk_bf16_f32 v74, v68, v69
  v_cvt_pk_bf16_f32 v75, v70, v71
  s_add_u32 s28, s21, 3
  s_add_u32 s29, s91, 33792
  s_cmp_ge_u32 s28, 86
  s_cselect_b32 s29, 0x40000000, s29
  s_cmp_eq_u32 s101, 1
  s_cbranch_scc1 L_interleave_layers__sliding_block__glu_gated_swiglu__prompt_33
  buffer_store_dwordx4 v[72:75], v1, s[12:15], s29 offen sc1
  s_branch L_interleave_layers__sliding_block__glu_gated_swiglu__prompt_34
L_interleave_layers__sliding_block__glu_gated_swiglu__prompt_33:
  buffer_store_dwordx4 v[72:75], v1, s[12:15], s29 offen
L_interleave_layers__sliding_block__glu_gated_swiglu__prompt_34:
  v_mfma_f32_32x32x16_bf16 v[32:47], v[92:95], v[212:215], v[32:47]
  ds_read_b128 v[88:91], v4 offset:31744
  ds_read_b128 v[92:95], v4 offset:35840
  s_waitcnt lgkmcnt(2)
  v_mfma_f32_32x32x16_bf16 v[16:31], v[80:83], v[216:219], v[16:31]
  v_mfma_f32_32x32x16_bf16 v[32:47], v[84:87], v[216:219], v[32:47]
  ds_read_b128 v[80:83], v4 offset:36864
  ds_read_b128 v[84:87], v4 offset:40960
  s_waitcnt lgkmcnt(2)
  v_mfma_f32_32x32x16_bf16 v[16:31], v[88:91], v[220:223], v[16:31]
  v_mfma_f32_32x32x16_bf16 v[32:47], v[92:95], v[220:223], v[32:47]
  ds_read_b128 v[88:91], v4 offset:37888
  ds_read_b128 v[92:95], v4 offset:41984
  s_waitcnt lgkmcnt(2)
  v_mfma_f32_32x32x16_bf16 v[16:31], v[80:83], v[224:227], v[16:31]
  v_mfma_f32_32x32x16_bf16 v[32:47], v[84:87], v[224:227], v[32:47]
  ds_read_b128 v[80:83], v4 offset:38912
  ds_read_b128 v[84:87], v4 offset:43008
  s_waitcnt lgkmcnt(2)
  v_mfma_f32_32x32x16_bf16 v[16:31], v[88:91], v[228:231], v[16:31]
  v_mfma_f32_32x32x16_bf16 v[32:47], v[92:95], v[228:231], v[32:47]
  ds_read_b128 v[88:91], v4 offset:39936
  ds_read_b128 v[92:95], v4 offset:44032
  s_waitcnt lgkmcnt(2)
  v_mfma_f32_32x32x16_bf16 v[16:31], v[80:83], v[232:235], v[16:31]
  v_mfma_f32_32x32x16_bf16 v[32:47], v[84:87], v[232:235], v[32:47]
  ds_read_b128 v[80:83], v4 offset:45056
  ds_read_b128 v[84:87], v4 offset:49152
  s_waitcnt lgkmcnt(2)
  v_mfma_f32_32x32x16_bf16 v[16:31], v[88:91], v[236:239], v[16:31]
  v_mfma_f32_32x32x16_bf16 v[32:47], v[92:95], v[236:239], v[32:47]
  ds_read_b128 v[88:91], v4 offset:46080
  ds_read_b128 v[92:95], v4 offset:50176
  s_waitcnt lgkmcnt(2)
  v_mfma_f32_32x32x16_bf16 v[16:31], v[80:83], v[240:243], v[16:31]
  v_mfma_f32_32x32x16_bf16 v[32:47], v[84:87], v[240:243], v[32:47]
  ds_read_b128 v[80:83], v4 offset:47104
  ds_read_b128 v[84:87], v4 offset:51200
  s_waitcnt lgkmcnt(2)
  v_mfma_f32_32x32x16_bf16 v[16:31], v[88:91], v[244:247], v[16:31]
  v_mfma_f32_32x32x16_bf16 v[32:47], v[92:95], v[244:247], v[32:47]
  ds_read_b128 v[88:91], v4 offset:48128
  ds_read_b128 v[92:95], v4 offset:52224
  s_waitcnt lgkmcnt(2)
  v_mfma_f32_32x32x16_bf16 v[16:31], v[80:83], v[248:251], v[16:31]
  v_mfma_f32_32x32x16_bf16 v[32:47], v[84:87], v[248:251], v[32:47]
  s_waitcnt lgkmcnt(0)
  v_mfma_f32_32x32x16_bf16 v[16:31], v[88:91], v[252:255], v[16:31]
  v_mfma_f32_32x32x16_bf16 v[32:47], v[92:95], v[252:255], v[32:47]
  s_lshl_b32 s28, s19, 13
  s_lshl_b32 s29, s17, 2
  s_add_u32 s28, s28, s29
  s_add_u32 s28, s28, 0x1100800
  v_mov_b32 v7, s98
  v_mov_b32 v8, 0
  s_waitcnt vmcnt(0)
  s_mov_b64 exec, 1
  s_cmp_eq_u32 s101, 1
  s_cbranch_scc1 L_interleave_layers__sliding_block__glu_gated_swiglu__prompt_35
  buffer_store_dword v7, v8, s[12:15], s28 offen sc1
  s_branch L_interleave_layers__sliding_block__glu_gated_swiglu__prompt_36
L_interleave_layers__sliding_block__glu_gated_swiglu__prompt_35:
  buffer_store_dword v7, v8, s[12:15], s28 offen
L_interleave_layers__sliding_block__glu_gated_swiglu__prompt_36:
  s_mov_b64 exec, -1
  s_nop 11
  v_pk_mul_f32 v[120:121], v[16:17], v[8:9] op_sel:[0,1] op_sel_hi:[1,1]
  v_pk_mul_f32 v[122:123], v[18:19], v[8:9] op_sel:[0,1] op_sel_hi:[1,1]
  v_pk_mul_f32 v[124:125], v[20:21], v[8:9] op_sel:[0,1] op_sel_hi:[1,1]
  v_pk_mul_f32 v[126:127], v[22:23], v[8:9] op_sel:[0,1] op_sel_hi:[1,1]
  v_exp_f32 v120, v120
  v_exp_f32 v121, v121
  v_pk_mul_f32 v[16:17], v[16:17], v[24:25] op_sel:[0,0] op_sel_hi:[1,1]
  v_exp_f32 v122, v122
  v_exp_f32 v123, v123
  v_pk_mul_f32 v[18:19], v[18:19], v[26:27] op_sel:[0,0] op_sel_hi:[1,1]
  v_exp_f32 v124, v124
  v_exp_f32 v125, v125
  v_pk_mul_f32 v[20:21], v[20:21], v[28:29] op_sel:[0,0] op_sel_hi:[1,1]
  v_exp_f32 v126, v126
  v_exp_f32 v127, v127
  v_pk_mul_f32 v[22:23], v[22:23], v[30:31] op_sel:[0,0] op_sel_hi:[1,1]
  v_pk_fma_f32 v[120:121], v[120:121], v[10:11], v[10:11] op_sel:[0,0,0] op_sel_hi:[1,0,0]
  v_pk_fma_f32 v[122:123], v[122:123], v[10:11], v[10:11] op_sel:[0,0,0] op_sel_hi:[1,0,0]
  v_pk_fma_f32 v[124:125], v[124:125], v[10:11], v[10:11] op_sel:[0,0,0] op_sel_hi:[1,0,0]
  v_pk_fma_f32 v[126:127], v[126:127], v[10:11], v[10:11] op_sel:[0,0,0] op_sel_hi:[1,0,0]
  v_rcp_f32 v120, v120
  v_rcp_f32 v121, v121
  v_rcp_f32 v122, v122
  v_rcp_f32 v123, v123
  v_rcp_f32 v124, v124
  v_rcp_f32 v125, v125
  v_rcp_f32 v126, v126
  v_rcp_f32 v127, v127
  s_nop 0
  v_pk_mul_f32 v[16:17], v[16:17], v[120:121] op_sel:[0,0] op_sel_hi:[1,1]
  v_pk_mul_f32 v[18:19], v[18:19], v[122:123] op_sel:[0,0] op_sel_hi:[1,1]
  v_pk_mul_f32 v[20:21], v[20:21], v[124:125] op_sel:[0,0] op_sel_hi:[1,1]
  v_pk_mul_f32 v[22:23], v[22:23], v[126:127] op_sel:[0,0] op_sel_hi:[1,1]
  v_cvt_pk_bf16_f32 v24, v16, v17
  v_cvt_pk_bf16_f32 v25, v18, v19
  v_cvt_pk_bf16_f32 v26, v20, v21
  v_cvt_pk_bf16_f32 v27, v22, v23
  s_add_u32 s28, s21, 4
  s_add_u32 s29, s91, 61440
  s_cmp_ge_u32 s28, 86
  s_cselect_b32 s29, 0x40000000, s29
  s_cmp_eq_u32 s101, 1
  s_cbranch_scc1 L_interleave_layers__sliding_block__glu_gated_swiglu__prompt_37
  buffer_store_dwordx4 v[24:27], v1, s[12:15], s29 offen sc1
  s_branch L_interleave_layers__sliding_block__glu_gated_swiglu__prompt_38
L_interleave_layers__sliding_block__glu_gated_swiglu__prompt_37:
  buffer_store_dwordx4 v[24:27], v1, s[12:15], s29 offen
L_interleave_layers__sliding_block__glu_gated_swiglu__prompt_38:
  v_pk_mul_f32 v[120:121], v[32:33], v[8:9] op_sel:[0,1] op_sel_hi:[1,1]
  v_pk_mul_f32 v[122:123], v[34:35], v[8:9] op_sel:[0,1] op_sel_hi:[1,1]
  v_pk_mul_f32 v[124:125], v[36:37], v[8:9] op_sel:[0,1] op_sel_hi:[1,1]
  v_pk_mul_f32 v[126:127], v[38:39], v[8:9] op_sel:[0,1] op_sel_hi:[1,1]
  v_exp_f32 v120, v120
  v_exp_f32 v121, v121
  v_pk_mul_f32 v[32:33], v[32:33], v[40:41] op_sel:[0,0] op_sel_hi:[1,1]
  v_exp_f32 v122, v122
  v_exp_f32 v123, v123
  v_pk_mul_f32 v[34:35], v[34:35], v[42:43] op_sel:[0,0] op_sel_hi:[1,1]
  v_exp_f32 v124, v124
  v_exp_f32 v125, v125
  v_pk_mul_f32 v[36:37], v[36:37], v[44:45] op_sel:[0,0] op_sel_hi:[1,1]
  v_exp_f32 v126, v126
  v_exp_f32 v127, v127
  v_pk_mul_f32 v[38:39], v[38:39], v[46:47] op_sel:[0,0] op_sel_hi:[1,1]
  v_pk_fma_f32 v[120:121], v[120:121], v[10:11], v[10:11] op_sel:[0,0,0] op_sel_hi:[1,0,0]
  v_pk_fma_f32 v[122:123], v[122:123], v[10:11], v[10:11] op_sel:[0,0,0] op_sel_hi:[1,0,0]
  v_pk_fma_f32 v[124:125], v[124:125], v[10:11], v[10:11] op_sel:[0,0,0] op_sel_hi:[1,0,0]
  v_pk_fma_f32 v[126:127], v[126:127], v[10:11], v[10:11] op_sel:[0,0,0] op_sel_hi:[1,0,0]
  v_rcp_f32 v120, v120
  v_rcp_f32 v121, v121
  v_rcp_f32 v122, v122
  v_rcp_f32 v123, v123
  v_rcp_f32 v124, v124
  v_rcp_f32 v125, v125
  v_rcp_f32 v126, v126
  v_rcp_f32 v127, v127
  s_nop 0
  v_pk_mul_f32 v[32:33], v[32:33], v[120:121] op_sel:[0,0] op_sel_hi:[1,1]
  v_pk_mul_f32 v[34:35], v[34:35], v[122:123] op_sel:[0,0] op_sel_hi:[1,1]
  v_pk_mul_f32 v[36:37], v[36:37], v[124:125] op_sel:[0,0] op_sel_hi:[1,1]
  v_pk_mul_f32 v[38:39], v[38:39], v[126:127] op_sel:[0,0] op_sel_hi:[1,1]
  v_cvt_pk_bf16_f32 v40, v32, v33
  v_cvt_pk_bf16_f32 v41, v34, v35
  v_cvt_pk_bf16_f32 v42, v36, v37
  v_cvt_pk_bf16_f32 v43, v38, v39
  s_add_u32 s28, s21, 5
  s_add_u32 s29, s91, 62464
  s_cmp_ge_u32 s28, 86
  s_cselect_b32 s29, 0x40000000, s29
  s_cmp_eq_u32 s101, 1
  s_cbranch_scc1 L_interleave_layers__sliding_block__glu_gated_swiglu__prompt_39
  buffer_store_dwordx4 v[40:43], v1, s[12:15], s29 offen sc1
  s_branch L_interleave_layers__sliding_block__glu_gated_swiglu__prompt_40
L_interleave_layers__sliding_block__glu_gated_swiglu__prompt_39:
  buffer_store_dwordx4 v[40:43], v1, s[12:15], s29 offen
L_interleave_layers__sliding_block__glu_gated_swiglu__prompt_40:
  s_lshl_b32 s28, s19, 13
  s_lshl_b32 s29, s17, 2
  s_add_u32 s28, s28, s29
  s_add_u32 s28, s28, 0x1101000
  v_mov_b32 v7, s98
  v_mov_b32 v8, 0
  s_waitcnt vmcnt(0)
  s_mov_b64 exec, 1
  s_cmp_eq_u32 s101, 1
  s_cbranch_scc1 L_interleave_layers__sliding_block__glu_gated_swiglu__prompt_41
  buffer_store_dword v7, v8, s[12:15], s28 offen sc1
  s_branch L_interleave_layers__sliding_block__glu_gated_swiglu__prompt_42
L_interleave_layers__sliding_block__glu_gated_swiglu__prompt_41:
  buffer_store_dword v7, v8, s[12:15], s28 offen
L_interleave_layers__sliding_block__glu_gated_swiglu__prompt_42:
  s_mov_b64 exec, -1
  s_barrier
  v_and_b32 v3, 31, v0
  v_min_u32 v3, 13, v3
  v_lshlrev_b32 v3, 2, v3
  v_lshrrev_b32 v9, 5, v0
  v_lshl_add_u32 v3, v9, 13, v3
  s_lshl_b32 s28, s16, 2
  s_and_b32 s29, s17, 1
  s_lshl_b32 s29, s29, 1
  s_add_u32 s28, s28, s29
  s_lshl_b32 s28, s28, 13
  s_add_u32 s28, s28, 0x1101000
  s_mov_b32 s31, 0
L_interleave_layers__sliding_block__glu_gated_swiglu__prompt_43:
  buffer_load_dword v6, v3, s[12:15], s28 offen sc1
  s_waitcnt vmcnt(0)
  v_cmp_eq_u32 vcc, s98, v6
  s_nop 1
  s_cmp_eq_u64 vcc, -1
  s_cbranch_scc1 L_interleave_layers__sliding_block__glu_gated_swiglu__prompt_44
  s_add_u32 s31, s31, 1
  s_cmp_lt_u32 s31, 0x20000
  s_cbranch_scc1 L_interleave_layers__sliding_block__glu_gated_swiglu__prompt_43
L_interleave_layers__sliding_block__glu_gated_swiglu__prompt_44:
  s_barrier
  s_add_u32 m0, s22, 65536
  s_add_u32 s30, s27, 57344
  buffer_load_dwordx4 v1, s[8:11], s30 offen offset:0  lds
  buffer_load_dwordx4 v1, s[8:11], s30 offen offset:1024  lds
  buffer_load_dwordx4 v1, s[8:11], s30 offen offset:2048  lds
  buffer_load_dwordx4 v1, s[8:11], s30 offen offset:3072  lds
  s_add_u32 m0, s22, 81920
  s_add_u32 s30, s27, 65536
  buffer_load_dwordx4 v1, s[8:11], s30 offen offset:0  lds
  buffer_load_dwordx4 v1, s[8:11], s30 offen offset:1024  lds
  buffer_load_dwordx4 v1, s[8:11], s30 offen offset:2048  lds
  buffer_load_dwordx4 v1, s[8:11], s30 offen offset:3072  lds
  s_add_u32 m0, s22, 98304
  s_add_u32 s30, s27, 73728
  buffer_load_dwordx4 v1, s[8:11], s30 offen offset:0  lds
  buffer_load_dwordx4 v1, s[8:11], s30 offen offset:1024  lds
  buffer_load_dwordx4 v1, s[8:11], s30 offen offset:2048  lds
  buffer_load_dwordx4 v1, s[8:11], s30 offen offset:3072  lds
  s_add_u32 m0, s22, 114688
  s_add_u32 s30, s27, 81920
  buffer_load_dwordx4 v1, s[8:11], s30 offen offset:0  lds
  buffer_load_dwordx4 v1, s[8:11], s30 offen offset:1024  lds
  buffer_load_dwordx4 v1, s[8:11], s30 offen offset:2048  lds
  buffer_load_dwordx4 v1, s[8:11], s30 offen offset:3072  lds
  s_setprio 0
  s_waitcnt vmcnt(0)
  s_barrier
  s_cmp_lg_u32 s20, 0
  s_cbranch_scc1 L_ekv
  s_add_u32 m0, s22, 0
  s_add_u32 s30, s99, 0
  s_and_b32 s30, s30, 0x7fff
  s_add_u32 s30, s30, s23
  buffer_load_dwordx4 v1, s[8:11], s30 offen offset:0  lds
  buffer_load_dwordx4 v1, s[8:11], s30 offen offset:1024  lds
  buffer_load_dwordx4 v1, s[8:11], s30 offen offset:2048  lds
  buffer_load_dwordx4 v1, s[8:11], s30 offen offset:3072  lds
  s_add_u32 m0, s22, 16384
  s_add_u32 s30, s99, 8192
  s_and_b32 s30, s30, 0x7fff
  s_add_u32 s30, s30, s23
  buffer_load_dwordx4 v1, s[8:11], s30 offen offset:0  lds
  buffer_load_dwordx4 v1, s[8:11], s30 offen offset:1024  lds
  buffer_load_dwordx4 v1, s[8:11], s30 offen offset:2048  lds
  buffer_load_dwordx4 v1, s[8:11], s30 offen offset:3072  lds
  s_add_u32 m0, s22, 32768
  s_add_u32 s30, s99, 16384
  s_and_b32 s30, s30, 0x7fff
  s_add_u32 s30, s30, s23
  buffer_load_dwordx4 v1, s[8:11], s30 offen offset:0  lds
  buffer_load_dwordx4 v1, s[8:11], s30 offen offset:1024  lds
  buffer_load_dwordx4 v1, s[8:11], s30 offen offset:2048  lds
  buffer_load_dwordx4 v1, s[8:11], s30 offen offset:3072  lds
L_ekv:
  s_barrier
  s_cmp_eq_u32 s20, 1
  s_cbranch_scc1 L_Cend
  s_barrier
  s_add_u32 m0, s22, 49152
  s_add_u32 s30, s99, 24576
  s_and_b32 s30, s30, 0x7fff
  s_add_u32 s30, s30, s23
  buffer_load_dwordx4 v1, s[8:11], s30 offen offset:0  lds
  buffer_load_dwordx4 v1, s[8:11], s30 offen offset:1024  lds
  buffer_load_dwordx4 v1, s[8:11], s30 offen offset:2048  lds
  buffer_load_dwordx4 v1, s[8:11], s30 offen offset:3072  lds
  s_mov_b32 s20, 1
  s_add_u32 s98, s98, 1
  s_min_u32 s101, s101, 1
  s_branch L_Ctop
L_Cend:
  s_or_b32 s28, s2, s3
  s_cmp_lg_u32 s28, 0
  s_cbranch_scc1 L_end
  s_load_dwordx2 s[24:25], s[0:1], 64
  s_waitcnt lgkmcnt(0)
  s_mov_b32 s26, 256
  s_mov_b32 s27, 0x20000
  v_mov_b32 v9, s98
  s_mov_b32 s98, 256
  v_mov_b32 v3, 0
  s_mov_b32 s28, 0
  s_mov_b32 s31, 0
L_interleave_layers__sliding_block__glu_gated_swiglu__prompt_45:
  buffer_load_dword v6, v3, s[24:27], s28 offen sc1
  s_waitcnt vmcnt(0)
  v_cmp_eq_u32 vcc, s98, v6
  s_nop 1
  s_cmp_eq_u64 vcc, -1
  s_cbranch_scc1 L_interleave_layers__sliding_block__glu_gated_swiglu__prompt_46
  s_add_u32 s31, s31, 1
  s_cmp_lt_u32 s31, 0x20000
  s_cbranch_scc1 L_interleave_layers__sliding_block__glu_gated_swiglu__prompt_45
L_interleave_layers__sliding_block__glu_gated_swiglu__prompt_46:
  s_mov_b32 s28, 0x4720000
  s_mov_b64 exec, 1
  buffer_store_dword v9, v3, s[8:11], s28 offen sc1
  s_endpgm
L_LP2:
  s_setprio 1
  s_mul_i32 s28, s94, 6144
  v_add_u32 v10, s28, v1
  s_lshl_b32 s28, s94, 11
  s_sub_u32 s28, 4096, s28
  v_add_u32 v11, s28, v1
  v_add_u32 v12, 61440, v10
  v_add_u32 v13, 61440, v11
  v_add_u32 v14, 122880, v10
  v_add_u32 v15, 122880, v11
  s_mul_i32 s90, s92, 32768
  s_lshl_b32 s29, s94, 11
  s_add_u32 s90, s90, 0x400000
  s_add_u32 s91, s90, s29
  v_min_u32 v3, 31, v0
  v_lshlrev_b32 v3, 2, v3
  s_lshl_b32 s28, s92, 12
  s_add_u32 s28, s28, 0x10c0000
  s_mov_b32 s31, 0
L_interleave_layers__sliding_block__glu_gated_swiglu__prompt_47:
  buffer_load_dword v6, v3, s[12:15], s28 offen sc1
  s_waitcnt vmcnt(0)
  v_cmp_eq_u32 vcc, s98, v6
  s_nop 1
  s_cmp_eq_u64 vcc, -1
  s_cbranch_scc1 L_interleave_layers__sliding_block__glu_gated_swiglu__prompt_48
  s_add_u32 s31, s31, 1
  s_cmp_lt_u32 s31, 0x20000
  s_cbranch_scc1 L_interleave_layers__sliding_block__glu_gated_swiglu__prompt_47
L_interleave_layers__sliding_block__glu_gated_swiglu__prompt_48:
  s_add_u32 s28, s91, 0
  buffer_load_dwordx4 v[64:67], v1, s[12:15], s28 offen offset:0 sc1
  buffer_load_dwordx4 v[68:71], v1, s[12:15], s28 offen offset:1024 sc1
  s_add_u32 s28, s91, 4096
  buffer_load_dwordx4 v[72:75], v1, s[12:15], s28 offen offset:0 sc1
  buffer_load_dwordx4 v[76:79], v1, s[12:15], s28 offen offset:1024 sc1
  s_add_u32 s28, s91, 8192
  buffer_load_dwordx4 v[80:83], v1, s[12:15], s28 offen offset:0 sc1
  buffer_load_dwordx4 v[84:87], v1, s[12:15], s28 offen offset:1024 sc1
  s_add_u32 s28, s91, 12288
  buffer_load_dwordx4 v[88:91], v1, s[12:15], s28 offen offset:0 sc1
  buffer_load_dwordx4 v[92:95], v1, s[12:15], s28 offen offset:1024 sc1
  s_add_u32 s28, s91, 16384
  buffer_load_dwordx4 v[96:99], v1, s[12:15], s28 offen offset:0 sc1
  buffer_load_dwordx4 v[100:103], v1, s[12:15], s28 offen offset:1024 sc1
  s_add_u32 s28, s91, 20480
  buffer_load_dwordx4 v[104:107], v1, s[12:15], s28 offen offset:0 sc1
  buffer_load_dwordx4 v[108:111], v1, s[12:15], s28 offen offset:1024 sc1
  s_add_u32 s28, s91, 24576
  buffer_load_dwordx4 v[112:115], v1, s[12:15], s28 offen offset:0 sc1
  buffer_load_dwordx4 v[116:119], v1, s[12:15], s28 offen offset:1024 sc1
  s_add_u32 s28, s91, 28672
  buffer_load_dwordx4 v[120:123], v1, s[12:15], s28 offen offset:0 sc1
  buffer_load_dwordx4 v[124:127], v1, s[12:15], s28 offen offset:1024 sc1
  ds_read_b128 v[48:51], v10 offset:0
  ds_read_b128 v[52:55], v11 offset:0
  ds_read_b128 v[56:59], v10 offset:1024
  ds_read_b128 v[60:63], v11 offset:1024
  s_waitcnt vmcnt(15) lgkmcnt(2)
  v_mfma_f32_32x32x16_bf16 v[32:47], v[52:55], v[64:67], 0
  v_mfma_f32_32x32x16_bf16 v[16:31], v[48:51], v[64:67], 0
  ds_read_b128 v[48:51], v10 offset:8192
  ds_read_b128 v[52:55], v11 offset:8192
  s_waitcnt vmcnt(14) lgkmcnt(2)
  v_mfma_f32_32x32x16_bf16 v[32:47], v[60:63], v[68:71], v[32:47]
  v_mfma_f32_32x32x16_bf16 v[16:31], v[56:59], v[68:71], v[16:31]
  ds_read_b128 v[56:59], v10 offset:9216
  ds_read_b128 v[60:63], v11 offset:9216
  s_waitcnt vmcnt(13) lgkmcnt(2)
  v_mfma_f32_32x32x16_bf16 v[32:47], v[52:55], v[72:75], v[32:47]
  v_mfma_f32_32x32x16_bf16 v[16:31], v[48:51], v[72:75], v[16:31]
  ds_read_b128 v[48:51], v10 offset:16384
  ds_read_b128 v[52:55], v11 offset:16384
  s_waitcnt vmcnt(12) lgkmcnt(2)
  v_mfma_f32_32x32x16_bf16 v[32:47], v[60:63], v[76:79], v[32:47]
  v_mfma_f32_32x32x16_bf16 v[16:31], v[56:59], v[76:79], v[16:31]
  ds_read_b128 v[56:59], v10 offset:17408
  ds_read_b128 v[60:63], v11 offset:17408
  s_waitcnt vmcnt(11) lgkmcnt(2)
  v_mfma_f32_32x32x16_bf16 v[32:47], v[52:55], v[80:83], v[32:47]
  v_mfma_f32_32x32x16_bf16 v[16:31], v[48:51], v[80:83], v[16:31]
  ds_read_b128 v[48:51], v10 offset:24576
  ds_read_b128 v[52:55], v11 offset:24576
  s_waitcnt vmcnt(10) lgkmcnt(2)
  v_mfma_f32_32x32x16_bf16 v[32:47], v[60:63], v[84:87], v[32:47]
  v_mfma_f32_32x32x16_bf16 v[16:31], v[56:59], v[84:87], v[16:31]
  ds_read_b128 v[56:59], v10 offset:25600
  ds_read_b128 v[60:63], v11 offset:25600
  s_waitcnt vmcnt(9) lgkmcnt(2)
  v_mfma_f32_32x32x16_bf16 v[32:47], v[52:55], v[88:91], v[32:47]
  v_mfma_f32_32x32x16_bf16 v[16:31], v[48:51], v[88:91], v[16:31]
  ds_read_b128 v[48:51], v10 offset:32768
  ds_read_b128 v[52:55], v11 offset:32768
  s_waitcnt vmcnt(8) lgkmcnt(2)
  v_mfma_f32_32x32x16_bf16 v[32:47], v[60:63], v[92:95], v[32:47]
  v_mfma_f32_32x32x16_bf16 v[16:31], v[56:59], v[92:95], v[16:31]
  ds_read_b128 v[56:59], v10 offset:33792
  ds_read_b128 v[60:63], v11 offset:33792
  s_waitcnt vmcnt(7) lgkmcnt(2)
  v_mfma_f32_32x32x16_bf16 v[32:47], v[52:55], v[96:99], v[32:47]
  v_mfma_f32_32x32x16_bf16 v[16:31], v[48:51], v[96:99], v[16:31]
  ds_read_b128 v[48:51], v10 offset:40960
  ds_read_b128 v[52:55], v11 offset:40960
  s_waitcnt vmcnt(6) lgkmcnt(2)
  v_mfma_f32_32x32x16_bf16 v[32:47], v[60:63], v[100:103], v[32:47]
  v_mfma_f32_32x32x16_bf16 v[16:31], v[56:59], v[100:103], v[16:31]
  ds_read_b128 v[56:59], v10 offset:41984
  ds_read_b128 v[60:63], v11 offset:41984
  s_waitcnt vmcnt(5) lgkmcnt(2)
  v_mfma_f32_32x32x16_bf16 v[32:47], v[52:55], v[104:107], v[32:47]
  v_mfma_f32_32x32x16_bf16 v[16:31], v[48:51], v[104:107], v[16:31]
  ds_read_b128 v[48:51], v10 offset:49152
  ds_read_b128 v[52:55], v11 offset:49152
  s_waitcnt vmcnt(4) lgkmcnt(2)
  v_mfma_f32_32x32x16_bf16 v[32:47], v[60:63], v[108:111], v[32:47]
  v_mfma_f32_32x32x16_bf16 v[16:31], v[56:59], v[108:111], v[16:31]
  ds_read_b128 v[56:59], v10 offset:50176
  ds_read_b128 v[60:63], v11 offset:50176
  s_waitcnt vmcnt(3) lgkmcnt(2)
  v_mfma_f32_32x32x16_bf16 v[32:47], v[52:55], v[112:115], v[32:47]
  v_mfma_f32_32x32x16_bf16 v[16:31], v[48:51], v[112:115], v[16:31]
  ds_read_b128 v[48:51], v10 offset:57344
  ds_read_b128 v[52:55], v11 offset:57344
  s_waitcnt vmcnt(2) lgkmcnt(2)
  v_mfma_f32_32x32x16_bf16 v[32:47], v[60:63], v[116:119], v[32:47]
  v_mfma_f32_32x32x16_bf16 v[16:31], v[56:59], v[116:119], v[16:31]
  ds_read_b128 v[56:59], v10 offset:58368
  ds_read_b128 v[60:63], v11 offset:58368
  s_waitcnt vmcnt(1) lgkmcnt(2)
  v_mfma_f32_32x32x16_bf16 v[32:47], v[52:55], v[120:123], v[32:47]
  v_mfma_f32_32x32x16_bf16 v[16:31], v[48:51], v[120:123], v[16:31]
  s_waitcnt vmcnt(0) lgkmcnt(0)
  v_mfma_f32_32x32x16_bf16 v[32:47], v[60:63], v[124:127], v[32:47]
  v_mfma_f32_32x32x16_bf16 v[16:31], v[56:59], v[124:127], v[16:31]
  s_add_u32 s28, s22, 98304
  v_add_u32 v3, s28, v1
  s_xor_b32 s28, s28, 4096
  v_add_u32 v6, s28, v1
  s_nop 7
  ds_write_b128 v3, v[32:35] offset:0
  ds_write_b128 v3, v[36:39] offset:1024
  ds_write_b128 v3, v[40:43] offset:2048
  ds_write_b128 v3, v[44:47] offset:3072
  v_lshlrev_b32 v8, 16, v248
  v_and_b32 v9, 0xffff0000, v248
  v_pk_add_f32 v[16:17], v[16:17], v[8:9] op_sel:[0,0] op_sel_hi:[1,1]
  v_lshlrev_b32 v8, 16, v249
  v_and_b32 v9, 0xffff0000, v249
  v_pk_add_f32 v[18:19], v[18:19], v[8:9] op_sel:[0,0] op_sel_hi:[1,1]
  v_lshlrev_b32 v8, 16, v250
  v_and_b32 v9, 0xffff0000, v250
  v_pk_add_f32 v[20:21], v[20:21], v[8:9] op_sel:[0,0] op_sel_hi:[1,1]
  v_lshlrev_b32 v8, 16, v251
  v_and_b32 v9, 0xffff0000, v251
  v_pk_add_f32 v[22:23], v[22:23], v[8:9] op_sel:[0,0] op_sel_hi:[1,1]
  v_lshlrev_b32 v8, 16, v252
  v_and_b32 v9, 0xffff0000, v252
  v_pk_add_f32 v[24:25], v[24:25], v[8:9] op_sel:[0,0] op_sel_hi:[1,1]
  v_lshlrev_b32 v8, 16, v253
  v_and_b32 v9, 0xffff0000, v253
  v_pk_add_f32 v[26:27], v[26:27], v[8:9] op_sel:[0,0] op_sel_hi:[1,1]
  v_lshlrev_b32 v8, 16, v254
  v_and_b32 v9, 0xffff0000, v254
  v_pk_add_f32 v[28:29], v[28:29], v[8:9] op_sel:[0,0] op_sel_hi:[1,1]
  v_lshlrev_b32 v8, 16, v255
  v_and_b32 v9, 0xffff0000, v255
  v_pk_add_f32 v[30:31], v[30:31], v[8:9] op_sel:[0,0] op_sel_hi:[1,1]
  s_waitcnt lgkmcnt(0)
  s_barrier
  ds_read_b128 v[32:35], v6 offset:0
  ds_read_b128 v[36:39], v6 offset:1024
  ds_read_b128 v[40:43], v6 offset:2048
  ds_read_b128 v[44:47], v6 offset:3072
  s_waitcnt lgkmcnt(3)
  v_pk_add_f32 v[16:17], v[16:17], v[32:33] op_sel:[0,0] op_sel_hi:[1,1]
  v_pk_add_f32 v[18:19], v[18:19], v[34:35] op_sel:[0,0] op_sel_hi:[1,1]
  v_cvt_pk_bf16_f32 v248, v16, v17
  v_cvt_pk_bf16_f32 v249, v18, v19
  s_waitcnt lgkmcnt(2)
  v_pk_add_f32 v[20:21], v[20:21], v[36:37] op_sel:[0,0] op_sel_hi:[1,1]
  v_pk_add_f32 v[22:23], v[22:23], v[38:39] op_sel:[0,0] op_sel_hi:[1,1]
  v_cvt_pk_bf16_f32 v250, v20, v21
  v_cvt_pk_bf16_f32 v251, v22, v23
  s_waitcnt lgkmcnt(1)
  v_pk_add_f32 v[24:25], v[24:25], v[40:41] op_sel:[0,0] op_sel_hi:[1,1]
  v_pk_add_f32 v[26:27], v[26:27], v[42:43] op_sel:[0,0] op_sel_hi:[1,1]
  v_cvt_pk_bf16_f32 v252, v24, v25
  v_cvt_pk_bf16_f32 v253, v26, v27
  s_waitcnt lgkmcnt(0)
  v_pk_add_f32 v[28:29], v[28:29], v[44:45] op_sel:[0,0] op_sel_hi:[1,1]
  v_pk_add_f32 v[30:31], v[30:31], v[46:47] op_sel:[0,0] op_sel_hi:[1,1]
  v_cvt_pk_bf16_f32 v254, v28, v29
  v_cvt_pk_bf16_f32 v255, v30, v31
  s_add_u32 s28, s95, 0x0
  s_cmp_eq_u32 s101, 1
  s_cbranch_scc1 L_interleave_layers__sliding_block__glu_gated_swiglu__prompt_49
  buffer_store_dwordx4 v[248:251], v1, s[12:15], s28 offen sc1
  buffer_store_dwordx4 v[252:255], v1, s[12:15], s28 offen offset:1024 sc1
  s_branch L_interleave_layers__sliding_block__glu_gated_swiglu__prompt_50
L_interleave_layers__sliding_block__glu_gated_swiglu__prompt_49:
  buffer_store_dwordx4 v[248:251], v1, s[12:15], s28 offen
  buffer_store_dwordx4 v[252:255], v1, s[12:15], s28 offen offset:1024
L_interleave_layers__sliding_block__glu_gated_swiglu__prompt_50:
  v_pk_add_f32 v[6:7], v[16:17], v[18:19] op_sel:[0,0] op_sel_hi:[1,1]
  v_pk_mul_f32 v[8:9], v[16:17], v[16:17] op_sel:[0,0] op_sel_hi:[1,1]
  v_pk_fma_f32 v[8:9], v[18:19], v[18:19], v[8:9] op_sel:[0,0,0] op_sel_hi:[1,1,1]
  v_pk_add_f32 v[6:7], v[6:7], v[20:21] op_sel:[0,0] op_sel_hi:[1,1]
  v_pk_fma_f32 v[8:9], v[20:21], v[20:21], v[8:9] op_sel:[0,0,0] op_sel_hi:[1,1,1]
  v_pk_add_f32 v[6:7], v[6:7], v[22:23] op_sel:[0,0] op_sel_hi:[1,1]
  v_pk_fma_f32 v[8:9], v[22:23], v[22:23], v[8:9] op_sel:[0,0,0] op_sel_hi:[1,1,1]
  v_pk_add_f32 v[6:7], v[6:7], v[24:25] op_sel:[0,0] op_sel_hi:[1,1]
  v_pk_fma_f32 v[8:9], v[24:25], v[24:25], v[8:9] op_sel:[0,0,0] op_sel_hi:[1,1,1]
  v_pk_add_f32 v[6:7], v[6:7], v[26:27] op_sel:[0,0] op_sel_hi:[1,1]
  v_pk_fma_f32 v[8:9], v[26:27], v[26:27], v[8:9] op_sel:[0,0,0] op_sel_hi:[1,1,1]
  v_pk_add_f32 v[6:7], v[6:7], v[28:29] op_sel:[0,0] op_sel_hi:[1,1]
  v_pk_fma_f32 v[8:9], v[28:29], v[28:29], v[8:9] op_sel:[0,0,0] op_sel_hi:[1,1,1]
  v_pk_add_f32 v[6:7], v[6:7], v[30:31] op_sel:[0,0] op_sel_hi:[1,1]
  v_pk_fma_f32 v[8:9], v[30:31], v[30:31], v[8:9] op_sel:[0,0,0] op_sel_hi:[1,1,1]
  v_add_f32 v6, v6, v7
  v_add_f32 v9, v8, v9
  s_nop 1
  v_permlane32_swap_b32 v6, v9
  s_nop 1
  v_add_f32 v6, v6, v9
  s_lshl_b32 s28, s92, 12
  s_lshr_b32 s29, s93, 2
  s_lshl_b32 s29, s29, 10
  s_add_u32 s28, s28, s29
  s_and_b32 s29, s93, 3
  s_lshl_b32 s29, s29, 2
  s_add_u32 s28, s28, s29
  s_add_u32 s28, s28, 0xf80000
  s_cmp_eq_u32 s101, 1
  s_cbranch_scc1 L_interleave_layers__sliding_block__glu_gated_swiglu__prompt_51
  buffer_store_dword v6, v1, s[12:15], s28 offen sc1
  s_branch L_interleave_layers__sliding_block__glu_gated_swiglu__prompt_52
L_interleave_layers__sliding_block__glu_gated_swiglu__prompt_51:
  buffer_store_dword v6, v1, s[12:15], s28 offen
L_interleave_layers__sliding_block__glu_gated_swiglu__prompt_52:
  s_lshl_b32 s28, s92, 11
  s_lshl_b32 s29, s93, 2
  s_add_u32 s28, s28, s29
  s_add_u32 s28, s28, 0x1080000
  v_mov_b32 v7, s98
  v_mov_b32 v8, 0
  s_waitcnt vmcnt(0)
  s_mov_b64 exec, 1
  s_cmp_eq_u32 s101, 1
  s_cbranch_scc1 L_interleave_layers__sliding_block__glu_gated_swiglu__prompt_53
  buffer_store_dword v7, v8, s[12:15], s28 offen sc1
  s_branch L_interleave_layers__sliding_block__glu_gated_swiglu__prompt_54
L_interleave_layers__sliding_block__glu_gated_swiglu__prompt_53:
  buffer_store_dword v7, v8, s[12:15], s28 offen
L_interleave_layers__sliding_block__glu_gated_swiglu__prompt_54:
  s_mov_b64 exec, -1
  s_setprio 0
  s_barrier
  s_barrier
  s_barrier
  s_add_u32 m0, s22, 49152
  s_add_u32 s30, s99, 0
  s_and_b32 s30, s30, 0x7fff
  s_add_u32 s30, s30, s26
  s_add_u32 s30, s30, 131072
  buffer_load_dwordx4 v1, s[8:11], s30 offen offset:0  lds
  buffer_load_dwordx4 v1, s[8:11], s30 offen offset:1024  lds
  buffer_load_dwordx4 v1, s[8:11], s30 offen offset:2048  lds
  buffer_load_dwordx4 v1, s[8:11], s30 offen offset:3072  lds
  s_add_u32 m0, s22, 65536
  s_add_u32 s30, s99, 8192
  s_and_b32 s30, s30, 0x7fff
  s_add_u32 s30, s30, s26
  s_add_u32 s30, s30, 131072
  buffer_load_dwordx4 v1, s[8:11], s30 offen offset:0  lds
  buffer_load_dwordx4 v1, s[8:11], s30 offen offset:1024  lds
  buffer_load_dwordx4 v1, s[8:11], s30 offen offset:2048  lds
  buffer_load_dwordx4 v1, s[8:11], s30 offen offset:3072  lds
  s_add_u32 m0, s22, 81920
  s_add_u32 s30, s99, 16384
  s_and_b32 s30, s30, 0x7fff
  s_add_u32 s30, s30, s26
  s_add_u32 s30, s30, 131072
  buffer_load_dwordx4 v1, s[8:11], s30 offen offset:0  lds
  buffer_load_dwordx4 v1, s[8:11], s30 offen offset:1024  lds
  buffer_load_dwordx4 v1, s[8:11], s30 offen offset:2048  lds
  buffer_load_dwordx4 v1, s[8:11], s30 offen offset:3072  lds
  s_add_u32 m0, s22, 98304
  s_add_u32 s30, s99, 24576
  s_and_b32 s30, s30, 0x7fff
  s_add_u32 s30, s30, s26
  s_add_u32 s30, s30, 131072
  buffer_load_dwordx4 v1, s[8:11], s30 offen offset:0  lds
  buffer_load_dwordx4 v1, s[8:11], s30 offen offset:1024  lds
  buffer_load_dwordx4 v1, s[8:11], s30 offen offset:2048  lds
  buffer_load_dwordx4 v1, s[8:11], s30 offen offset:3072  lds
  s_add_u32 m0, s22, 114688
  s_add_u32 s30, s27, 0
  buffer_load_dwordx4 v1, s[8:11], s30 offen offset:0  lds
  buffer_load_dwordx4 v1, s[8:11], s30 offen offset:1024  lds
  buffer_load_dwordx4 v1, s[8:11], s30 offen offset:2048  lds
  buffer_load_dwordx4 v1, s[8:11], s30 offen offset:3072  lds
  s_waitcnt vmcnt(12)
  s_barrier
  s_add_u32 m0, s22, 131072
  s_add_u32 s30, s27, 8192
  buffer_load_dwordx4 v1, s[8:11], s30 offen offset:0  lds
  buffer_load_dwordx4 v1, s[8:11], s30 offen offset:1024  lds
  buffer_load_dwordx4 v1, s[8:11], s30 offen offset:2048  lds
  buffer_load_dwordx4 v1, s[8:11], s30 offen offset:3072  lds
  s_add_u32 m0, s22, 147456
  s_add_u32 s30, s27, 16384
  buffer_load_dwordx4 v1, s[8:11], s30 offen offset:0  lds
  buffer_load_dwordx4 v1, s[8:11], s30 offen offset:1024  lds
  buffer_load_dwordx4 v1, s[8:11], s30 offen offset:2048  lds
  buffer_load_dwordx4 v1, s[8:11], s30 offen offset:3072  lds
  s_add_u32 m0, s22, 0
  s_add_u32 s30, s27, 24576
  buffer_load_dwordx4 v1, s[8:11], s30 offen offset:0  lds
  buffer_load_dwordx4 v1, s[8:11], s30 offen offset:1024  lds
  buffer_load_dwordx4 v1, s[8:11], s30 offen offset:2048  lds
  buffer_load_dwordx4 v1, s[8:11], s30 offen offset:3072  lds
  s_add_u32 m0, s22, 16384
  s_add_u32 s30, s27, 32768
  buffer_load_dwordx4 v1, s[8:11], s30 offen offset:0  lds
  buffer_load_dwordx4 v1, s[8:11], s30 offen offset:1024  lds
  buffer_load_dwordx4 v1, s[8:11], s30 offen offset:2048  lds
  buffer_load_dwordx4 v1, s[8:11], s30 offen offset:3072  lds
  s_waitcnt vmcnt(20)
  s_barrier
  s_add_u32 m0, s22, 32768
  s_add_u32 s30, s27, 40960
  buffer_load_dwordx4 v1, s[8:11], s30 offen offset:0  lds
  buffer_load_dwordx4 v1, s[8:11], s30 offen offset:1024  lds
  buffer_load_dwordx4 v1, s[8:11], s30 offen offset:2048  lds
  buffer_load_dwordx4 v1, s[8:11], s30 offen offset:3072  lds
  s_add_u32 m0, s22, 49152
  s_add_u32 s30, s27, 49152
  buffer_load_dwordx4 v1, s[8:11], s30 offen offset:0  lds
  buffer_load_dwordx4 v1, s[8:11], s30 offen offset:1024  lds
  buffer_load_dwordx4 v1, s[8:11], s30 offen offset:2048  lds
  buffer_load_dwordx4 v1, s[8:11], s30 offen offset:3072  lds
  s_setprio 0
  s_mul_i32 s28, s94, 6144
  v_add_u32 v10, s28, v1
  s_lshl_b32 s28, s94, 11
  s_sub_u32 s28, 4096, s28
  v_add_u32 v11, s28, v1
  v_add_u32 v12, 61440, v10
  v_add_u32 v13, 61440, v11
  v_add_u32 v14, 122880, v10
  v_add_u32 v15, 122880, v11
  s_mul_i32 s90, s92, 90112
  s_lshl_b32 s29, s94, 11
  s_add_u32 s90, s90, 0xa00000
  s_add_u32 s91, s90, s29
  v_min_u32 v3, 14, v0
  v_lshlrev_b32 v3, 2, v3
  s_lshl_b32 s28, s92, 13
  s_add_u32 s28, s28, 0x1100000
  s_mov_b32 s31, 0
L_interleave_layers__sliding_block__glu_gated_swiglu__prompt_55:
  buffer_load_dword v6, v3, s[12:15], s28 offen sc1
  s_waitcnt vmcnt(0)
  v_cmp_eq_u32 vcc, s98, v6
  s_nop 1
  s_cmp_eq_u64 vcc, -1
  s_cbranch_scc1 L_interleave_layers__sliding_block__glu_gated_swiglu__prompt_56
  s_add_u32 s31, s31, 1
  s_cmp_lt_u32 s31, 0x20000
  s_cbranch_scc1 L_interleave_layers__sliding_block__glu_gated_swiglu__prompt_55
L_interleave_layers__sliding_block__glu_gated_swiglu__prompt_56:
  s_add_u32 s28, s91, 0
  buffer_load_dwordx4 v[64:67], v1, s[12:15], s28 offen offset:0 sc1
  buffer_load_dwordx4 v[68:71], v1, s[12:15], s28 offen offset:1024 sc1
  s_add_u32 s28, s91, 4096
  buffer_load_dwordx4 v[72:75], v1, s[12:15], s28 offen offset:0 sc1
  buffer_load_dwordx4 v[76:79], v1, s[12:15], s28 offen offset:1024 sc1
  s_add_u32 s28, s91, 8192
  buffer_load_dwordx4 v[80:83], v1, s[12:15], s28 offen offset:0 sc1
  buffer_load_dwordx4 v[84:87], v1, s[12:15], s28 offen offset:1024 sc1
  s_add_u32 s28, s91, 12288
  buffer_load_dwordx4 v[88:91], v1, s[12:15], s28 offen offset:0 sc1
  buffer_load_dwordx4 v[92:95], v1, s[12:15], s28 offen offset:1024 sc1
  s_add_u32 s28, s91, 16384
  buffer_load_dwordx4 v[96:99], v1, s[12:15], s28 offen offset:0 sc1
  buffer_load_dwordx4 v[100:103], v1, s[12:15], s28 offen offset:1024 sc1
  s_add_u32 s28, s91, 20480
  buffer_load_dwordx4 v[104:107], v1, s[12:15], s28 offen offset:0 sc1
  buffer_load_dwordx4 v[108:111], v1, s[12:15], s28 offen offset:1024 sc1
  s_add_u32 s28, s91, 24576
  buffer_load_dwordx4 v[112:115], v1, s[12:15], s28 offen offset:0 sc1
  buffer_load_dwordx4 v[116:119], v1, s[12:15], s28 offen offset:1024 sc1
  s_add_u32 s28, s90, 28672
  buffer_load_dwordx4 v[120:123], v1, s[12:15], s28 offen offset:0 sc1
  buffer_load_dwordx4 v[124:127], v1, s[12:15], s28 offen offset:1024 sc1
  v_min_u32 v3, 13, v0
  v_lshlrev_b32 v3, 2, v3
  s_lshl_b32 s28, s92, 13
  s_add_u32 s28, s28, 0x1100800
  s_mov_b32 s31, 0
L_interleave_layers__sliding_block__glu_gated_swiglu__prompt_57:
  buffer_load_dword v6, v3, s[12:15], s28 offen sc1
  s_waitcnt vmcnt(0)
  v_cmp_eq_u32 vcc, s98, v6
  s_nop 1
  s_cmp_eq_u64 vcc, -1
  s_cbranch_scc1 L_interleave_layers__sliding_block__glu_gated_swiglu__prompt_58
  s_add_u32 s31, s31, 1
  s_cmp_lt_u32 s31, 0x20000
  s_cbranch_scc1 L_interleave_layers__sliding_block__glu_gated_swiglu__prompt_57
L_interleave_layers__sliding_block__glu_gated_swiglu__prompt_58:
  s_add_u32 s28, s91, 32768
  buffer_load_dwordx4 v[128:131], v1, s[12:15], s28 offen offset:0 sc1
  buffer_load_dwordx4 v[132:135], v1, s[12:15], s28 offen offset:1024 sc1
  s_add_u32 s28, s91, 36864
  buffer_load_dwordx4 v[136:139], v1, s[12:15], s28 offen offset:0 sc1
  buffer_load_dwordx4 v[140:143], v1, s[12:15], s28 offen offset:1024 sc1
  s_add_u32 s28, s91, 40960
  buffer_load_dwordx4 v[144:147], v1, s[12:15], s28 offen offset:0 sc1
  buffer_load_dwordx4 v[148:151], v1, s[12:15], s28 offen offset:1024 sc1
  s_add_u32 s28, s91, 45056
  buffer_load_dwordx4 v[152:155], v1, s[12:15], s28 offen offset:0 sc1
  buffer_load_dwordx4 v[156:159], v1, s[12:15], s28 offen offset:1024 sc1
  s_add_u32 s28, s91, 49152
  buffer_load_dwordx4 v[160:163], v1, s[12:15], s28 offen offset:0 sc1
  buffer_load_dwordx4 v[164:167], v1, s[12:15], s28 offen offset:1024 sc1
  s_add_u32 s28, s91, 53248
  buffer_load_dwordx4 v[168:171], v1, s[12:15], s28 offen offset:0 sc1
  buffer_load_dwordx4 v[172:175], v1, s[12:15], s28 offen offset:1024 sc1
  s_add_u32 s28, s91, 57344
  buffer_load_dwordx4 v[176:179], v1, s[12:15], s28 offen offset:0 sc1
  buffer_load_dwordx4 v[180:183], v1, s[12:15], s28 offen offset:1024 sc1
  s_barrier
  ds_read_b128 v[48:51], v12 offset:53248
  ds_read_b128 v[52:55], v13 offset:53248
  ds_read_b128 v[56:59], v12 offset:54272
  ds_read_b128 v[60:63], v13 offset:54272
  s_waitcnt vmcnt(29) lgkmcnt(2)
  v_mfma_f32_32x32x16_bf16 v[32:47], v[52:55], v[64:67], 0
  v_mfma_f32_32x32x16_bf16 v[16:31], v[48:51], v[64:67], 0
  ds_read_b128 v[48:51], v14 offset:0
  ds_read_b128 v[52:55], v15 offset:0
  s_waitcnt vmcnt(28) lgkmcnt(2)
  v_mfma_f32_32x32x16_bf16 v[32:47], v[60:63], v[68:71], v[32:47]
  v_mfma_f32_32x32x16_bf16 v[16:31], v[56:59], v[68:71], v[16:31]
  ds_read_b128 v[56:59], v14 offset:1024
  ds_read_b128 v[60:63], v15 offset:1024
  s_waitcnt vmcnt(27) lgkmcnt(2)
  v_mfma_f32_32x32x16_bf16 v[32:47], v[52:55], v[72:75], v[32:47]
  v_mfma_f32_32x32x16_bf16 v[16:31], v[48:51], v[72:75], v[16:31]
  ds_read_b128 v[48:51], v14 offset:8192
  ds_read_b128 v[52:55], v15 offset:8192
  s_waitcnt vmcnt(26) lgkmcnt(2)
  v_mfma_f32_32x32x16_bf16 v[32:47], v[60:63], v[76:79], v[32:47]
  v_mfma_f32_32x32x16_bf16 v[16:31], v[56:59], v[76:79], v[16:31]
  ds_read_b128 v[56:59], v14 offset:9216
  ds_read_b128 v[60:63], v15 offset:9216
  s_waitcnt vmcnt(25) lgkmcnt(2)
  v_mfma_f32_32x32x16_bf16 v[32:47], v[52:55], v[80:83], v[32:47]
  v_mfma_f32_32x32x16_bf16 v[16:31], v[48:51], v[80:83], v[16:31]
  ds_read_b128 v[48:51], v14 offset:16384
  ds_read_b128 v[52:55], v15 offset:16384
  s_waitcnt vmcnt(24) lgkmcnt(2)
  v_mfma_f32_32x32x16_bf16 v[32:47], v[60:63], v[84:87], v[32:47]
  v_mfma_f32_32x32x16_bf16 v[16:31], v[56:59], v[84:87], v[16:31]
  ds_read_b128 v[56:59], v14 offset:17408
  ds_read_b128 v[60:63], v15 offset:17408
  s_waitcnt vmcnt(23) lgkmcnt(2)
  v_mfma_f32_32x32x16_bf16 v[32:47], v[52:55], v[88:91], v[32:47]
  v_mfma_f32_32x32x16_bf16 v[16:31], v[48:51], v[88:91], v[16:31]
  ds_read_b128 v[48:51], v14 offset:24576
  ds_read_b128 v[52:55], v15 offset:24576
  s_waitcnt vmcnt(22) lgkmcnt(2)
  v_mfma_f32_32x32x16_bf16 v[32:47], v[60:63], v[92:95], v[32:47]
  v_mfma_f32_32x32x16_bf16 v[16:31], v[56:59], v[92:95], v[16:31]
  ds_read_b128 v[56:59], v14 offset:25600
  ds_read_b128 v[60:63], v15 offset:25600
  s_waitcnt vmcnt(21) lgkmcnt(2)
  v_mfma_f32_32x32x16_bf16 v[32:47], v[52:55], v[96:99], v[32:47]
  v_mfma_f32_32x32x16_bf16 v[16:31], v[48:51], v[96:99], v[16:31]
  ds_read_b128 v[48:51], v14 offset:32768
  ds_read_b128 v[52:55], v15 offset:32768
  s_waitcnt vmcnt(20) lgkmcnt(2)
  v_mfma_f32_32x32x16_bf16 v[32:47], v[60:63], v[100:103], v[32:47]
  v_mfma_f32_32x32x16_bf16 v[16:31], v[56:59], v[100:103], v[16:31]
  ds_read_b128 v[56:59], v14 offset:33792
  ds_read_b128 v[60:63], v15 offset:33792
  s_waitcnt vmcnt(19) lgkmcnt(2)
  v_mfma_f32_32x32x16_bf16 v[32:47], v[52:55], v[104:107], v[32:47]
  v_mfma_f32_32x32x16_bf16 v[16:31], v[48:51], v[104:107], v[16:31]
  ds_read_b128 v[48:51], v10 offset:0
  ds_read_b128 v[52:55], v11 offset:0
  s_waitcnt vmcnt(18) lgkmcnt(2)
  v_mfma_f32_32x32x16_bf16 v[32:47], v[60:63], v[108:111], v[32:47]
  v_mfma_f32_32x32x16_bf16 v[16:31], v[56:59], v[108:111], v[16:31]
  ds_read_b128 v[56:59], v10 offset:1024
  ds_read_b128 v[60:63], v11 offset:1024
  s_waitcnt vmcnt(17) lgkmcnt(2)
  v_mfma_f32_32x32x16_bf16 v[32:47], v[52:55], v[112:115], v[32:47]
  v_mfma_f32_32x32x16_bf16 v[16:31], v[48:51], v[112:115], v[16:31]
  ds_read_b128 v[48:51], v10 offset:8192
  ds_read_b128 v[52:55], v11 offset:8192
  s_waitcnt vmcnt(16) lgkmcnt(2)
  v_mfma_f32_32x32x16_bf16 v[32:47], v[60:63], v[116:119], v[32:47]
  v_mfma_f32_32x32x16_bf16 v[16:31], v[56:59], v[116:119], v[16:31]
  ds_read_b128 v[56:59], v10 offset:9216
  ds_read_b128 v[60:63], v11 offset:9216
  s_waitcnt vmcnt(15) lgkmcnt(2)
  v_mfma_f32_32x32x16_bf16 v[32:47], v[52:55], v[120:123], v[32:47]
  v_mfma_f32_32x32x16_bf16 v[16:31], v[48:51], v[120:123], v[16:31]
  ds_read_b128 v[48:51], v10 offset:16384
  ds_read_b128 v[52:55], v11 offset:16384
  s_waitcnt vmcnt(14) lgkmcnt(2)
  v_mfma_f32_32x32x16_bf16 v[32:47], v[60:63], v[124:127], v[32:47]
  v_mfma_f32_32x32x16_bf16 v[16:31], v[56:59], v[124:127], v[16:31]
  s_barrier
  s_add_u32 s28, s91, 61440
  buffer_load_dwordx4 v[184:187], v1, s[12:15], s28 offen offset:0 sc1
  buffer_load_dwordx4 v[188:191], v1, s[12:15], s28 offen offset:1024 sc1
  s_add_u32 s28, s91, 65536
  buffer_load_dwordx4 v[192:195], v1, s[12:15], s28 offen offset:0 sc1
  buffer_load_dwordx4 v[196:199], v1, s[12:15], s28 offen offset:1024 sc1
  s_add_u32 s28, s91, 69632
  buffer_load_dwordx4 v[200:203], v1, s[12:15], s28 offen offset:0 sc1
  buffer_load_dwordx4 v[204:207], v1, s[12:15], s28 offen offset:1024 sc1
  s_add_u32 s28, s91, 73728
  buffer_load_dwordx4 v[208:211], v1, s[12:15], s28 offen offset:0 sc1
  buffer_load_dwordx4 v[212:215], v1, s[12:15], s28 offen offset:1024 sc1
  s_add_u32 s28, s91, 77824
  buffer_load_dwordx4 v[216:219], v1, s[12:15], s28 offen offset:0 sc1
  buffer_load_dwordx4 v[220:223], v1, s[12:15], s28 offen offset:1024 sc1
  s_add_u32 s28, s91, 81920
  buffer_load_dwordx4 v[224:227], v1, s[12:15], s28 offen offset:0 sc1
  buffer_load_dwordx4 v[228:231], v1, s[12:15], s28 offen offset:1024 sc1
  s_add_u32 s28, s91, 86016
  buffer_load_dwordx4 v[232:235], v1, s[12:15], s28 offen offset:0 sc1
  buffer_load_dwordx4 v[236:239], v1, s[12:15], s28 offen offset:1024 sc1
  ds_read_b128 v[56:59], v10 offset:17408
  ds_read_b128 v[60:63], v11 offset:17408
  s_waitcnt vmcnt(27) lgkmcnt(2)
  v_mfma_f32_32x32x16_bf16 v[32:47], v[52:55], v[128:131], v[32:47]
  v_mfma_f32_32x32x16_bf16 v[16:31], v[48:51], v[128:131], v[16:31]
  ds_read_b128 v[48:51], v10 offset:24576
  ds_read_b128 v[52:55], v11 offset:24576
  s_waitcnt vmcnt(26) lgkmcnt(2)
  v_mfma_f32_32x32x16_bf16 v[32:47], v[60:63], v[132:135], v[32:47]
  v_mfma_f32_32x32x16_bf16 v[16:31], v[56:59], v[132:135], v[16:31]
  ds_read_b128 v[56:59], v10 offset:25600
  ds_read_b128 v[60:63], v11 offset:25600
  s_waitcnt vmcnt(25) lgkmcnt(2)
  v_mfma_f32_32x32x16_bf16 v[32:47], v[52:55], v[136:139], v[32:47]
  v_mfma_f32_32x32x16_bf16 v[16:31], v[48:51], v[136:139], v[16:31]
  ds_read_b128 v[48:51], v10 offset:32768
  ds_read_b128 v[52:55], v11 offset:32768
  s_waitcnt vmcnt(24) lgkmcnt(2)
  v_mfma_f32_32x32x16_bf16 v[32:47], v[60:63], v[140:143], v[32:47]
  v_mfma_f32_32x32x16_bf16 v[16:31], v[56:59], v[140:143], v[16:31]
  ds_read_b128 v[56:59], v10 offset:33792
  ds_read_b128 v[60:63], v11 offset:33792
  s_waitcnt vmcnt(23) lgkmcnt(2)
  v_mfma_f32_32x32x16_bf16 v[32:47], v[52:55], v[144:147], v[32:47]
  v_mfma_f32_32x32x16_bf16 v[16:31], v[48:51], v[144:147], v[16:31]
  ds_read_b128 v[48:51], v10 offset:40960
  ds_read_b128 v[52:55], v11 offset:40960
  s_waitcnt vmcnt(22) lgkmcnt(2)
  v_mfma_f32_32x32x16_bf16 v[32:47], v[60:63], v[148:151], v[32:47]
  v_mfma_f32_32x32x16_bf16 v[16:31], v[56:59], v[148:151], v[16:31]
  ds_read_b128 v[56:59], v10 offset:41984
  ds_read_b128 v[60:63], v11 offset:41984
  s_waitcnt vmcnt(21) lgkmcnt(2)
  v_mfma_f32_32x32x16_bf16 v[32:47], v[52:55], v[152:155], v[32:47]
  v_mfma_f32_32x32x16_bf16 v[16:31], v[48:51], v[152:155], v[16:31]
  ds_read_b128 v[48:51], v10 offset:49152
  ds_read_b128 v[52:55], v11 offset:49152
  s_waitcnt vmcnt(20) lgkmcnt(2)
  v_mfma_f32_32x32x16_bf16 v[32:47], v[60:63], v[156:159], v[32:47]
  v_mfma_f32_32x32x16_bf16 v[16:31], v[56:59], v[156:159], v[16:31]
  ds_read_b128 v[56:59], v10 offset:50176
  ds_read_b128 v[60:63], v11 offset:50176
  s_waitcnt vmcnt(19) lgkmcnt(2)
  v_mfma_f32_32x32x16_bf16 v[32:47], v[52:55], v[160:163], v[32:47]
  v_mfma_f32_32x32x16_bf16 v[16:31], v[48:51], v[160:163], v[16:31]
  ds_read_b128 v[48:51], v10 offset:57344
  ds_read_b128 v[52:55], v11 offset:57344
  s_waitcnt vmcnt(18) lgkmcnt(2)
  v_mfma_f32_32x32x16_bf16 v[32:47], v[60:63], v[164:167], v[32:47]
  v_mfma_f32_32x32x16_bf16 v[16:31], v[56:59], v[164:167], v[16:31]
  ds_read_b128 v[56:59], v10 offset:58368
  ds_read_b128 v[60:63], v11 offset:58368
  s_waitcnt vmcnt(17) lgkmcnt(2)
  v_mfma_f32_32x32x16_bf16 v[32:47], v[52:55], v[168:171], v[32:47]
  v_mfma_f32_32x32x16_bf16 v[16:31], v[48:51], v[168:171], v[16:31]
  s_barrier
  ds_read_b128 v[48:51], v12 offset:4096
  ds_read_b128 v[52:55], v13 offset:4096
  s_waitcnt vmcnt(16) lgkmcnt(2)
  v_mfma_f32_32x32x16_bf16 v[32:47], v[60:63], v[172:175], v[32:47]
  v_mfma_f32_32x32x16_bf16 v[16:31], v[56:59], v[172:175], v[16:31]
  ds_read_b128 v[56:59], v12 offset:5120
  ds_read_b128 v[60:63], v13 offset:5120
  s_waitcnt vmcnt(15) lgkmcnt(2)
  v_mfma_f32_32x32x16_bf16 v[32:47], v[52:55], v[176:179], v[32:47]
  v_mfma_f32_32x32x16_bf16 v[16:31], v[48:51], v[176:179], v[16:31]
  ds_read_b128 v[48:51], v12 offset:12288
  ds_read_b128 v[52:55], v13 offset:12288
  s_waitcnt vmcnt(14) lgkmcnt(2)
  v_mfma_f32_32x32x16_bf16 v[32:47], v[60:63], v[180:183], v[32:47]
  v_mfma_f32_32x32x16_bf16 v[16:31], v[56:59], v[180:183], v[16:31]
  ds_read_b128 v[56:59], v12 offset:13312
  ds_read_b128 v[60:63], v13 offset:13312
  s_waitcnt vmcnt(13) lgkmcnt(2)
  v_mfma_f32_32x32x16_bf16 v[32:47], v[52:55], v[184:187], v[32:47]
  v_mfma_f32_32x32x16_bf16 v[16:31], v[48:51], v[184:187], v[16:31]
  ds_read_b128 v[48:51], v12 offset:20480
  ds_read_b128 v[52:55], v13 offset:20480
  s_waitcnt vmcnt(12) lgkmcnt(2)
  v_mfma_f32_32x32x16_bf16 v[32:47], v[60:63], v[188:191], v[32:47]
  v_mfma_f32_32x32x16_bf16 v[16:31], v[56:59], v[188:191], v[16:31]
  ds_read_b128 v[56:59], v12 offset:21504
  ds_read_b128 v[60:63], v13 offset:21504
  s_waitcnt vmcnt(11) lgkmcnt(2)
  v_mfma_f32_32x32x16_bf16 v[32:47], v[52:55], v[192:195], v[32:47]
  v_mfma_f32_32x32x16_bf16 v[16:31], v[48:51], v[192:195], v[16:31]
  ds_read_b128 v[48:51], v12 offset:28672
  ds_read_b128 v[52:55], v13 offset:28672
  s_waitcnt vmcnt(10) lgkmcnt(2)
  v_mfma_f32_32x32x16_bf16 v[32:47], v[60:63], v[196:199], v[32:47]
  v_mfma_f32_32x32x16_bf16 v[16:31], v[56:59], v[196:199], v[16:31]
  ds_read_b128 v[56:59], v12 offset:29696
  ds_read_b128 v[60:63], v13 offset:29696
  s_waitcnt vmcnt(9) lgkmcnt(2)
  v_mfma_f32_32x32x16_bf16 v[32:47], v[52:55], v[200:203], v[32:47]
  v_mfma_f32_32x32x16_bf16 v[16:31], v[48:51], v[200:203], v[16:31]
  ds_read_b128 v[48:51], v12 offset:36864
  ds_read_b128 v[52:55], v13 offset:36864
  s_waitcnt vmcnt(8) lgkmcnt(2)
  v_mfma_f32_32x32x16_bf16 v[32:47], v[60:63], v[204:207], v[32:47]
  v_mfma_f32_32x32x16_bf16 v[16:31], v[56:59], v[204:207], v[16:31]
  ds_read_b128 v[56:59], v12 offset:37888
  ds_read_b128 v[60:63], v13 offset:37888
  s_waitcnt vmcnt(7) lgkmcnt(2)
  v_mfma_f32_32x32x16_bf16 v[32:47], v[52:55], v[208:211], v[32:47]
  v_mfma_f32_32x32x16_bf16 v[16:31], v[48:51], v[208:211], v[16:31]
  ds_read_b128 v[48:51], v12 offset:45056
  ds_read_b128 v[52:55], v13 offset:45056
  s_waitcnt vmcnt(6) lgkmcnt(2)
  v_mfma_f32_32x32x16_bf16 v[32:47], v[60:63], v[212:215], v[32:47]
  v_mfma_f32_32x32x16_bf16 v[16:31], v[56:59], v[212:215], v[16:31]
  ds_read_b128 v[56:59], v12 offset:46080
  ds_read_b128 v[60:63], v13 offset:46080
  s_waitcnt vmcnt(5) lgkmcnt(2)
  v_mfma_f32_32x32x16_bf16 v[32:47], v[52:55], v[216:219], v[32:47]
  v_mfma_f32_32x32x16_bf16 v[16:31], v[48:51], v[216:219], v[16:31]
  ds_read_b128 v[48:51], v12 offset:53248
  ds_read_b128 v[52:55], v13 offset:53248
  s_waitcnt vmcnt(4) lgkmcnt(2)
  v_mfma_f32_32x32x16_bf16 v[32:47], v[60:63], v[220:223], v[32:47]
  v_mfma_f32_32x32x16_bf16 v[16:31], v[56:59], v[220:223], v[16:31]
  ds_read_b128 v[56:59], v12 offset:54272
  ds_read_b128 v[60:63], v13 offset:54272
  s_waitcnt vmcnt(3) lgkmcnt(2)
  v_mfma_f32_32x32x16_bf16 v[32:47], v[52:55], v[224:227], v[32:47]
  v_mfma_f32_32x32x16_bf16 v[16:31], v[48:51], v[224:227], v[16:31]
  ds_read_b128 v[48:51], v14 offset:0
  ds_read_b128 v[52:55], v15 offset:0
  s_waitcnt vmcnt(2) lgkmcnt(2)
  v_mfma_f32_32x32x16_bf16 v[32:47], v[60:63], v[228:231], v[32:47]
  v_mfma_f32_32x32x16_bf16 v[16:31], v[56:59], v[228:231], v[16:31]
  ds_read_b128 v[56:59], v14 offset:1024
  ds_read_b128 v[60:63], v15 offset:1024
  s_waitcnt vmcnt(1) lgkmcnt(2)
  v_mfma_f32_32x32x16_bf16 v[32:47], v[52:55], v[232:235], v[32:47]
  v_mfma_f32_32x32x16_bf16 v[16:31], v[48:51], v[232:235], v[16:31]
  s_waitcnt vmcnt(0) lgkmcnt(0)
  v_mfma_f32_32x32x16_bf16 v[32:47], v[60:63], v[236:239], v[32:47]
  v_mfma_f32_32x32x16_bf16 v[16:31], v[56:59], v[236:239], v[16:31]
  s_add_u32 s28, s22, 131072
  v_add_u32 v3, s28, v1
  s_xor_b32 s28, s28, 4096
  v_add_u32 v6, s28, v1
  s_nop 7
  ds_write_b128 v3, v[32:35] offset:0
  ds_write_b128 v3, v[36:39] offset:1024
  ds_write_b128 v3, v[40:43] offset:2048
  ds_write_b128 v3, v[44:47] offset:3072
  v_lshlrev_b32 v8, 16, v248
  v_and_b32 v9, 0xffff0000, v248
  v_pk_add_f32 v[16:17], v[16:17], v[8:9] op_sel:[0,0] op_sel_hi:[1,1]
  v_lshlrev_b32 v8, 16, v249
  v_and_b32 v9, 0xffff0000, v249
  v_pk_add_f32 v[18:19], v[18:19], v[8:9] op_sel:[0,0] op_sel_hi:[1,1]
  v_lshlrev_b32 v8, 16, v250
  v_and_b32 v9, 0xffff0000, v250
  v_pk_add_f32 v[20:21], v[20:21], v[8:9] op_sel:[0,0] op_sel_hi:[1,1]
  v_lshlrev_b32 v8, 16, v251
  v_and_b32 v9, 0xffff0000, v251
  v_pk_add_f32 v[22:23], v[22:23], v[8:9] op_sel:[0,0] op_sel_hi:[1,1]
  v_lshlrev_b32 v8, 16, v252
  v_and_b32 v9, 0xffff0000, v252
  v_pk_add_f32 v[24:25], v[24:25], v[8:9] op_sel:[0,0] op_sel_hi:[1,1]
  v_lshlrev_b32 v8, 16, v253
  v_and_b32 v9, 0xffff0000, v253
  v_pk_add_f32 v[26:27], v[26:27], v[8:9] op_sel:[0,0] op_sel_hi:[1,1]
  v_lshlrev_b32 v8, 16, v254
  v_and_b32 v9, 0xffff0000, v254
  v_pk_add_f32 v[28:29], v[28:29], v[8:9] op_sel:[0,0] op_sel_hi:[1,1]
  v_lshlrev_b32 v8, 16, v255
  v_and_b32 v9, 0xffff0000, v255
  v_pk_add_f32 v[30:31], v[30:31], v[8:9] op_sel:[0,0] op_sel_hi:[1,1]
  s_waitcnt lgkmcnt(0)
  s_barrier
  ds_read_b128 v[32:35], v6 offset:0
  ds_read_b128 v[36:39], v6 offset:1024
  ds_read_b128 v[40:43], v6 offset:2048
  ds_read_b128 v[44:47], v6 offset:3072
  s_waitcnt lgkmcnt(3)
  v_pk_add_f32 v[16:17], v[16:17], v[32:33] op_sel:[0,0] op_sel_hi:[1,1]
  v_pk_add_f32 v[18:19], v[18:19], v[34:35] op_sel:[0,0] op_sel_hi:[1,1]
  v_cvt_pk_bf16_f32 v248, v16, v17
  v_cvt_pk_bf16_f32 v249, v18, v19
  s_waitcnt lgkmcnt(2)
  v_pk_add_f32 v[20:21], v[20:21], v[36:37] op_sel:[0,0] op_sel_hi:[1,1]
  v_pk_add_f32 v[22:23], v[22:23], v[38:39] op_sel:[0,0] op_sel_hi:[1,1]
  v_cvt_pk_bf16_f32 v250, v20, v21
  v_cvt_pk_bf16_f32 v251, v22, v23
  s_waitcnt lgkmcnt(1)
  v_pk_add_f32 v[24:25], v[24:25], v[40:41] op_sel:[0,0] op_sel_hi:[1,1]
  v_pk_add_f32 v[26:27], v[26:27], v[42:43] op_sel:[0,0] op_sel_hi:[1,1]
  v_cvt_pk_bf16_f32 v252, v24, v25
  v_cvt_pk_bf16_f32 v253, v26, v27
  s_waitcnt lgkmcnt(0)
  v_pk_add_f32 v[28:29], v[28:29], v[44:45] op_sel:[0,0] op_sel_hi:[1,1]
  v_pk_add_f32 v[30:31], v[30:31], v[46:47] op_sel:[0,0] op_sel_hi:[1,1]
  v_cvt_pk_bf16_f32 v254, v28, v29
  v_cvt_pk_bf16_f32 v255, v30, v31
  s_cmp_eq_u32 s20, 1
  s_cbranch_scc1 L_Lfinal
  s_add_u32 s98, s98, 1
  s_min_u32 s101, s101, 1
  s_add_u32 s28, s95, 0x0
  s_cmp_eq_u32 s101, 1
  s_cbranch_scc1 L_interleave_layers__sliding_block__glu_gated_swiglu__prompt_59
  buffer_store_dwordx4 v[248:251], v1, s[12:15], s28 offen sc1
  buffer_store_dwordx4 v[252:255], v1, s[12:15], s28 offen offset:1024 sc1
  s_branch L_interleave_layers__sliding_block__glu_gated_swiglu__prompt_60
L_interleave_layers__sliding_block__glu_gated_swiglu__prompt_59:
  buffer_store_dwordx4 v[248:251], v1, s[12:15], s28 offen
  buffer_store_dwordx4 v[252:255], v1, s[12:15], s28 offen offset:1024
L_interleave_layers__sliding_block__glu_gated_swiglu__prompt_60:
  v_pk_add_f32 v[6:7], v[16:17], v[18:19] op_sel:[0,0] op_sel_hi:[1,1]
  v_pk_mul_f32 v[8:9], v[16:17], v[16:17] op_sel:[0,0] op_sel_hi:[1,1]
  v_pk_fma_f32 v[8:9], v[18:19], v[18:19], v[8:9] op_sel:[0,0,0] op_sel_hi:[1,1,1]
  v_pk_add_f32 v[6:7], v[6:7], v[20:21] op_sel:[0,0] op_sel_hi:[1,1]
  v_pk_fma_f32 v[8:9], v[20:21], v[20:21], v[8:9] op_sel:[0,0,0] op_sel_hi:[1,1,1]
  v_pk_add_f32 v[6:7], v[6:7], v[22:23] op_sel:[0,0] op_sel_hi:[1,1]
  v_pk_fma_f32 v[8:9], v[22:23], v[22:23], v[8:9] op_sel:[0,0,0] op_sel_hi:[1,1,1]
  v_pk_add_f32 v[6:7], v[6:7], v[24:25] op_sel:[0,0] op_sel_hi:[1,1]
  v_pk_fma_f32 v[8:9], v[24:25], v[24:25], v[8:9] op_sel:[0,0,0] op_sel_hi:[1,1,1]
  v_pk_add_f32 v[6:7], v[6:7], v[26:27] op_sel:[0,0] op_sel_hi:[1,1]
  v_pk_fma_f32 v[8:9], v[26:27], v[26:27], v[8:9] op_sel:[0,0,0] op_sel_hi:[1,1,1]
  v_pk_add_f32 v[6:7], v[6:7], v[28:29] op_sel:[0,0] op_sel_hi:[1,1]
  v_pk_fma_f32 v[8:9], v[28:29], v[28:29], v[8:9] op_sel:[0,0,0] op_sel_hi:[1,1,1]
  v_pk_add_f32 v[6:7], v[6:7], v[30:31] op_sel:[0,0] op_sel_hi:[1,1]
  v_pk_fma_f32 v[8:9], v[30:31], v[30:31], v[8:9] op_sel:[0,0,0] op_sel_hi:[1,1,1]
  v_add_f32 v6, v6, v7
  v_add_f32 v9, v8, v9
  s_nop 1
  v_permlane32_swap_b32 v6, v9
  s_nop 1
  v_add_f32 v6, v6, v9
  s_lshl_b32 s28, s92, 12
  s_lshr_b32 s29, s93, 2
  s_lshl_b32 s29, s29, 10
  s_add_u32 s28, s28, s29
  s_and_b32 s29, s93, 3
  s_lshl_b32 s29, s29, 2
  s_add_u32 s28, s28, s29
  s_add_u32 s28, s28, 0xf80000
  s_cmp_eq_u32 s101, 1
  s_cbranch_scc1 L_interleave_layers__sliding_block__glu_gated_swiglu__prompt_61
  buffer_store_dword v6, v1, s[12:15], s28 offen sc1
  s_branch L_interleave_layers__sliding_block__glu_gated_swiglu__prompt_62
L_interleave_layers__sliding_block__glu_gated_swiglu__prompt_61:
  buffer_store_dword v6, v1, s[12:15], s28 offen
L_interleave_layers__sliding_block__glu_gated_swiglu__prompt_62:
  s_lshl_b32 s28, s92, 11
  s_lshl_b32 s29, s93, 2
  s_add_u32 s28, s28, s29
  s_add_u32 s28, s28, 0x1000000
  v_mov_b32 v7, s98
  v_mov_b32 v8, 0
  s_waitcnt vmcnt(0)
  s_mov_b64 exec, 1
  s_cmp_eq_u32 s101, 1
  s_cbranch_scc1 L_interleave_layers__sliding_block__glu_gated_swiglu__prompt_63
  buffer_store_dword v7, v8, s[12:15], s28 offen sc1
  s_branch L_interleave_layers__sliding_block__glu_gated_swiglu__prompt_64
L_interleave_layers__sliding_block__glu_gated_swiglu__prompt_63:
  buffer_store_dword v7, v8, s[12:15], s28 offen
L_interleave_layers__sliding_block__glu_gated_swiglu__prompt_64:
  s_mov_b64 exec, -1
  s_barrier
  s_mov_b32 s20, 1
  s_branch L_Ltop
L_Lfinal:
  s_mov_b32 s28, s6
  s_mov_b32 s29, s7
  s_mov_b32 s30, 0x200000
  s_mov_b32 s31, 0x20000
  v_and_b32 v6, 31, v0
  v_lshlrev_b32 v6, 10, v6
  v_lshrrev_b32 v7, 5, v0
  v_lshl_add_u32 v6, v7, 4, v6
  s_lshl_b32 s90, s92, 15
  s_lshl_b32 s91, s93, 6
  s_add_u32 s90, s90, s91
  v_permlane32_swap_b32 v248, v250
  v_permlane32_swap_b32 v249, v251
  v_permlane32_swap_b32 v252, v254
  v_permlane32_swap_b32 v253, v255
  s_nop 1
  buffer_store_dwordx4 v[248:251], v6, s[28:31], s90 offen offset:0
  buffer_store_dwordx4 v[252:255], v6, s[28:31], s90 offen offset:32
L_end:
  s_endpgm
.section .rodata,"a"
.p2align 6
.amdhsa_kernel interleave_layers__sliding_block__glu_gated_swiglu__prompt_kernel
  .amdhsa_next_free_vgpr 256
  .amdhsa_next_free_sgpr 102
  .amdhsa_accum_offset 256
  .amdhsa_group_segment_fixed_size 0
  .amdhsa_kernarg_size 80
  .amdhsa_user_sgpr_count 2
  .amdhsa_user_sgpr_kernarg_segment_ptr 1
  .amdhsa_system_sgpr_workgroup_id_x 1
.end_amdhsa_kernel
```
